```python
import torch

def _softmax(x, axis=-1):
    return torch.softmax(x, dim=axis)
def _gelu(x):
    return torch.nn.functional.gelu(x, approximate="tanh")
def _silu(x):
    return torch.nn.functional.silu(x)
def _sigmoid(x):
    return torch.sigmoid(x)
def _layernorm(x, axis=-1, eps=1e-5):
    m = x.mean(dim=axis, keepdim=True)
    v = x.var(dim=axis, keepdim=True, unbiased=False)
    return (x - m) / torch.sqrt(v + eps)
def _scatter_add(tgt, idx, src, axis=0):
    return tgt.clone().index_add_(axis, idx, src)
def _segment_sum(src, seg, n):
    out = torch.zeros((n,) + src.shape[1:], dtype=src.dtype)
    return out.index_add_(0, seg, src)
def _pad(x, pw):
    flat = tuple(v for pair in reversed(pw) for v in pair)
    return torch.nn.functional.pad(x, flat)

kernel_name = 'gated_mix__softmax_full_mha__geglu_ffn__prompt'

def setup_inputs():

    _w = (lambda a: (lambda t: t.to(torch.bfloat16) if t.is_floating_point() else t)(torch.as_tensor(a)))
    def _A_setup():
        B, S, D = 1, 2048, 512
        return {
            "x": _w((lambda *s: torch.randn(*s, dtype=torch.bfloat16) * 0.05)(B, S, D)),
            "wqkv": _w((lambda *s: torch.randn(*s, dtype=torch.bfloat16) * 0.8)(D, 3 * D)),
            "wo": _w((lambda *s: torch.randn(*s, dtype=torch.bfloat16) * 0.05)(D, D)),
        }
    _A_in = _A_setup()

    def _B_setup():
        B, S, D, F = 1, 2048, 512, 1376
        return {
            "x": _w((lambda *s: torch.randn(*s, dtype=torch.bfloat16) * 0.05)(B, S, D)),
            "w_gate": _w((lambda *s: torch.randn(*s, dtype=torch.bfloat16) * 0.1)(D, F)),
            "w_up": _w((lambda *s: torch.randn(*s, dtype=torch.bfloat16) * 0.1)(D, F)),
            "w_down": _w((lambda *s: torch.randn(*s, dtype=torch.bfloat16) * 0.1)(F, D)),
        }
    _B_in = _B_setup()

    return {
        "A_x": _A_in["x"],
        "A_wqkv": _A_in["wqkv"],
        "A_wo": _A_in["wo"],
        "B_x": _B_in["x"],
        "B_w_gate": _B_in["w_gate"],
        "B_w_up": _B_in["w_up"],
        "B_w_down": _B_in["w_down"],
        "gate_w": _w((lambda *s: torch.randn(*s, dtype=torch.bfloat16) * 0.05)(512) * 16.0),
    }

def reference(A_x, A_wqkv, A_wo, B_x, B_w_gate, B_w_up, B_w_down, gate_w):
    def _A_ref(x, wqkv, wo):
        B, S, D = x.shape
        H = 32; Dh = D // H
        qkv = (lambda x, *d: x.permute(*d))((x @ wqkv).reshape(B, S, 3, H, Dh), 2, 0, 3, 1, 4)
        q, k, v = qkv[0], qkv[1], qkv[2]
        scale = Dh ** -0.5
        scores = torch.einsum("bhqd,bhkd->bhqk", q, k) * scale
        p = _softmax(scores, axis=-1)
        o = torch.einsum("bhqk,bhkd->bhqd", p, v)
        return (lambda x, *d: x.permute(*d))(o, 0, 2, 1, 3).reshape(B, S, D) @ wo

    def _B_ref(x, w_gate, w_up, w_down):
        return (_gelu(x @ w_gate) * (x @ w_up)) @ w_down

    x = A_x
    g = _sigmoid((x * gate_w).sum(-1, keepdims=True))
    a = _A_ref(x, A_wqkv, A_wo)
    b = _B_ref(x, B_w_gate, B_w_up, B_w_down)
    return g * a + (1 - g) * b
```

```asm
; @launch grid=(256,1,1) block=(512,1,1) lds=163840
.amdgcn_target "amdgcn-amd-amdhsa--gfx950"
.text
.globl gated_mix__softmax_full_mha__geglu_ffn__prompt_kernel
.p2align 12
.p2align 8
.type gated_mix__softmax_full_mha__geglu_ffn__prompt_kernel,@function
gated_mix__softmax_full_mha__geglu_ffn__prompt_kernel:
    s_cmp_ge_u32 s2, 256
    s_cbranch_scc1 L_end
    s_load_dwordx4 s[48:51], s[0:1], 0
    s_load_dwordx4 s[52:55], s[0:1], 16
    s_load_dwordx8 s[56:63], s[0:1], 32
    s_load_dwordx4 s[64:67], s[0:1], 64
    s_load_dwordx2 s[68:69], s[0:1], 80
    v_lshrrev_b32 v1, 6, v0
    v_and_b32 v0, 63, v0
    s_and_b32 s76, s2, 7
    v_readfirstlane_b32 s3, v1
    s_lshr_b32 s77, s2, 3
    s_and_b32 s78, s76, 1
    s_lshl_b32 s78, s78, 3
    s_and_b32 s79, s77, 7
    s_add_u32 s42, s78, s79
    s_mul_i32 s92, s79, 1
    s_lshr_b32 s78, s76, 1
    s_lshl_b32 s78, s78, 2
    s_lshr_b32 s79, s77, 3
    s_add_u32 s43, s78, s79
    s_mul_i32 s79, s79, 2
    s_add_u32 s92, s92, s79
    s_lshr_b32 s45, s77, 2
    s_and_b32 s79, s77, 3
    s_and_b32 s92, s92, 7
    s_lshl_b32 s78, s76, 2
    s_add_u32 s44, s78, s79
    s_lshr_b32 s78, s76, 1
    s_lshl_b32 s78, s78, 3
    s_and_b32 s79, s77, 7
    s_add_u32 s46, s78, s79
    s_and_b32 s78, s76, 1
    s_lshl_b32 s78, s78, 2
    s_lshr_b32 s79, s77, 3
    s_add_u32 s47, s78, s79
    v_lshrrev_b32 v2, 3, v0
    v_lshlrev_b32 v2, 10, v2
    v_lshrrev_b32 v3, 4, v0
    v_xor_b32 v3, v3, v0
    v_and_b32 v3, 7, v3
    v_lshl_add_u32 v2, v3, 4, v2
    v_xor_b32 v3, 64, v2
    v_add_u32 v3, 0x2000, v3
    s_lshl_b32 s94, s42, 17
    s_lshl_b32 s78, s3, 14
    s_add_u32 s94, s94, s78
    s_lshl_b32 s73, s3, 11
    s_lshl_b32 s78, s3, 1
    s_sub_u32 s78, s78, 4
    s_cmp_lt_u32 s3, 4
    s_cselect_b32 s78, s3, s78
    s_lshl_b32 s74, s78, 10
    s_add_u32 s74, s74, 16384
    s_lshl_b32 s78, s78, 6
    s_mov_b32 s79, 3072
    v_add_u32 v10, s78, v0
    v_mul_u32_u24 v11, 43691, v10
    v_lshrrev_b32 v11, 19, v11
    v_mul_u32_u24 v12, 12, v11
    v_sub_u32 v10, v10, v12
    v_mul_u32_u24 v11, 3072, v11
    v_lshl_add_u32 v4, v10, 4, v11
    v_add_u32 v10, s78, v0
    v_add_u32 v10, 64, v10
    v_mul_u32_u24 v11, 43691, v10
    v_lshrrev_b32 v11, 19, v11
    v_mul_u32_u24 v12, 12, v11
    v_sub_u32 v10, v10, v12
    v_mul_u32_u24 v11, 3072, v11
    v_lshl_add_u32 v5, v10, 4, v11
    s_mul_i32 s95, s43, 192
    s_waitcnt lgkmcnt(0)
    s_mov_b32 s4, s48
    s_mov_b32 s5, s49
    s_mov_b32 s6, 0x200000
    s_mov_b32 s7, 0x00020000
    s_mov_b32 s8, s50
    s_mov_b32 s9, s51
    s_mov_b32 s10, 0x180000
    s_mov_b32 s11, 0x00020000
    s_add_u32 s93, s92, 0
    s_and_b32 s93, s93, 7
    s_lshl_b32 s70, s93, 7
    s_mul_i32 s71, s93, 196608
    s_add_u32 s70, s70, s94
    s_add_u32 s71, s71, s95
    s_add_u32 m0, s73, 0
    s_nop 0
    buffer_load_dwordx4 v2, s[4:7], s70 offen lds
    s_add_u32 m0, s73, 1024
    s_nop 0
    buffer_load_dwordx4 v3, s[4:7], s70 offen lds
    s_add_u32 m0, s74, 0
    s_nop 0
    buffer_load_dwordx4 v4, s[8:11], s71 offen lds
    s_cmp_lt_u32 s3, 4
    s_cbranch_scc1 L_w1_1
    s_add_u32 m0, s74, 1024
    s_nop 0
    buffer_load_dwordx4 v5, s[8:11], s71 offen lds
L_w1_1:
    s_add_u32 s93, s92, 1
    s_and_b32 s93, s93, 7
    s_lshl_b32 s70, s93, 7
    s_mul_i32 s71, s93, 196608
    s_add_u32 s70, s70, s94
    s_add_u32 s71, s71, s95
    s_add_u32 m0, s73, 28672
    s_nop 0
    buffer_load_dwordx4 v2, s[4:7], s70 offen lds
    s_add_u32 m0, s73, 29696
    s_nop 0
    buffer_load_dwordx4 v3, s[4:7], s70 offen lds
    s_add_u32 m0, s74, 28672
    s_nop 0
    buffer_load_dwordx4 v4, s[8:11], s71 offen lds
    s_cmp_lt_u32 s3, 4
    s_cbranch_scc1 L_w1_2
    s_add_u32 m0, s74, 29696
    s_nop 0
    buffer_load_dwordx4 v5, s[8:11], s71 offen lds
L_w1_2:
    s_cmp_lt_u32 s3, 4
    s_cselect_b32 s12, s56, s58
    s_cselect_b32 s13, s57, s59
    s_mov_b32 s14, 0x158000
    s_mov_b32 s15, 0x00020000
    s_mov_b32 s16, s60
    s_mov_b32 s17, s61
    s_mov_b32 s18, 0x158000
    s_mov_b32 s19, 0x00020000
    s_mov_b32 s20, s52
    s_mov_b32 s21, s53
    s_mov_b32 s22, 0x80000
    s_mov_b32 s23, 0x00020000
    s_mov_b32 s24, s68
    s_mov_b32 s25, s69
    s_mov_b32 s26, 0x1000000
    s_mov_b32 s27, 0x00020000
    s_mov_b32 s28, s64
    s_mov_b32 s29, s65
    s_mov_b32 s30, 0x200000
    s_mov_b32 s31, 0x00020000
    s_mov_b32 s32, s66
    s_mov_b32 s33, s67
    s_mov_b32 s34, 0x100
    s_mov_b32 s35, 0x00020000
    s_mov_b32 s36, s62
    s_mov_b32 s37, s63
    s_mov_b32 s38, 0x400
    s_mov_b32 s39, 0x00020000
    s_mov_b32 s40, 0x0000ffff
    s_mov_b32 s41, 0x0000ffff
    v_lshlrev_b32 v1, 4, v0
    v_mov_b32 v126, 0
    v_mov_b32 v20, 0
    v_mov_b32 v21, 0
    v_mov_b32 v22, 0
    v_mov_b32 v23, 0
    v_mov_b32 v24, -1
    v_mov_b32 v25, -1
    v_mov_b32 v26, -1
    v_mov_b32 v27, -1
    s_cmp_ge_u32 s2, 2
    s_cbranch_scc1 L_z_3
    s_lshl_b32 s76, s2, 3
    s_add_u32 s76, s76, s3
    s_lshl_b32 s76, s76, 10
    s_add_u32 s76, s76, 0xe80000
    buffer_store_dwordx4 v[20:23], v1, s[24:27], s76 offen sc1
L_z_3:
    s_lshl_b32 s76, s45, 3
    s_add_u32 s76, s76, s3
    s_lshl_b32 s76, s76, 5
    s_add_u32 s76, s76, s44
    s_lshl_b32 s76, s76, 10
    s_add_u32 s76, s76, 6291456
    buffer_store_dwordx4 v[24:27], v1, s[24:27], s76 offen sc1
    s_lshl_b32 s76, s43, 9
    s_lshr_b32 s77, s42, 2
    s_lshl_b32 s77, s77, 7
    s_add_u32 s76, s76, s77
    s_and_b32 s77, s42, 3
    s_lshl_b32 s77, s77, 2
    s_add_u32 s76, s76, s77
    s_add_u32 s85, s76, 0xe80000
    s_lshl_b32 s76, s42, 9
    s_lshr_b32 s77, s43, 2
    s_lshl_b32 s77, s77, 7
    s_add_u32 s76, s76, s77
    s_and_b32 s77, s43, 3
    s_lshl_b32 s77, s77, 2
    s_add_u32 s76, s76, s77
    s_add_u32 s86, s76, 0xe82000
    v_add_u32 v10, 0, v0
    v_mul_u32_u24 v11, 43691, v10
    v_lshrrev_b32 v11, 19, v11
    v_mul_u32_u24 v12, 12, v11
    v_sub_u32 v10, v10, v12
    v_mul_u32_u24 v11, 2752, v11
    v_lshl_add_u32 v6, v10, 4, v11
    v_add_u32 v10, 64, v0
    v_mul_u32_u24 v11, 43691, v10
    v_lshrrev_b32 v11, 19, v11
    v_mul_u32_u24 v12, 12, v11
    v_sub_u32 v10, v10, v12
    v_mul_u32_u24 v11, 2752, v11
    v_lshl_add_u32 v7, v10, 4, v11
    v_add_u32 v10, 128, v0
    v_mul_u32_u24 v11, 43691, v10
    v_lshrrev_b32 v11, 19, v11
    v_mul_u32_u24 v12, 12, v11
    v_sub_u32 v10, v10, v12
    v_mul_u32_u24 v11, 2752, v11
    v_lshl_add_u32 v8, v10, 4, v11
    s_and_b32 s76, s3, 3
    s_lshr_b32 s77, s3, 2
    s_mul_i32 s78, s43, 6
    s_min_u32 s78, s78, 80
    s_lshl_b32 s78, s78, 5
    s_mul_i32 s79, s76, 44032
    s_add_u32 s96, s78, s79
    s_mul_i32 s78, s77, 12320
    s_mul_i32 s79, s76, 3072
    s_add_u32 s75, s78, s79
    v_and_b32 v10, 31, v0
    v_lshlrev_b32 v10, 7, v10
    v_lshrrev_b32 v11, 5, v0
    v_lshrrev_b32 v12, 1, v0
    v_and_b32 v12, 7, v12
    v_xor_b32 v12, v12, v11
    v_lshl_add_u32 v10, v12, 4, v10
    s_lshl_b32 s78, s76, 12
    v_add_u32 v9, s78, v10
    v_bfe_u32 v12, v0, 2, 2
    v_lshl_add_u32 v12, v11, 3, v12
    v_mul_u32_u24 v12, 192, v12
    v_and_b32 v13, 3, v0
    v_lshl_add_u32 v12, v13, 3, v12
    v_bfe_u32 v13, v0, 4, 1
    v_lshl_add_u32 v10, v13, 5, v12
    s_lshl_b32 s78, s77, 7
    s_add_u32 s78, s78, 16384
    v_add_u32 v14, s78, v10
    v_mul_u32_u24 v10, 12320, v13
    v_add_u32 v10, v10, v12
    s_mul_i32 s78, s77, 96
    v_add_u32 v18, s78, v10
    v_lshlrev_b32 v10, 16, v13
    v_lshl_add_u32 v10, v11, 8, v10
    v_and_b32 v12, 15, v0
    v_lshl_add_u32 v17, v12, 4, v10
    v_and_b32 v10, 0x33, v0
    v_bfe_u32 v12, v0, 2, 1
    v_lshl_add_u32 v10, v12, 3, v10
    v_bfe_u32 v12, v0, 3, 1
    v_lshl_add_u32 v10, v12, 2, v10
    v_lshlrev_b32 v19, 4, v10
    s_cmp_ge_u32 s3, 4
    s_cbranch_scc1 L_ch1
    s_cmp_ge_u32 s43, 11
    s_cbranch_scc1 L_A0V
    s_waitcnt vmcnt(4)
    s_barrier
    v_add_u32 v10, 0, v9
    v_xor_b32 v11, 32, v10
    v_xor_b32 v12, 64, v10
    v_xor_b32 v13, 96, v10
    v_add_u32 v16, 0, v14
    ds_read_b128 a[0:3], v10
    ds_read_b64_tr_b16 v[20:21], v16 offset:0
    ds_read_b64_tr_b16 v[22:23], v16 offset:768
    ds_read_b64_tr_b16 v[24:25], v16 offset:64
    ds_read_b64_tr_b16 v[26:27], v16 offset:832
    s_add_u32 s93, s92, 2
    s_and_b32 s93, s93, 7
    s_lshl_b32 s70, s93, 7
    s_mul_i32 s71, s93, 196608
    s_add_u32 s70, s70, s94
    s_add_u32 s71, s71, s95
    s_add_u32 m0, s73, 57344
    s_nop 0
    buffer_load_dwordx4 v2, s[4:7], s70 offen lds
    s_add_u32 m0, s73, 58368
    s_nop 0
    buffer_load_dwordx4 v3, s[4:7], s70 offen lds
    s_add_u32 m0, s74, 57344
    s_nop 0
    buffer_load_dwordx4 v4, s[8:11], s71 offen lds
    ds_read_b128 a[4:7], v11
    ds_read_b64_tr_b16 v[32:33], v16 offset:3072
    ds_read_b64_tr_b16 v[34:35], v16 offset:3840
    ds_read_b64_tr_b16 v[36:37], v16 offset:3136
    ds_read_b64_tr_b16 v[38:39], v16 offset:3904
    s_waitcnt lgkmcnt(5)
    v_mfma_f32_32x32x16_bf16 v[44:59], v[20:23], a[0:3], 0
    v_mfma_f32_32x32x16_bf16 v[60:75], v[24:27], a[0:3], 0
    s_add_u32 s93, s92, 3
    s_and_b32 s93, s93, 7
    s_lshl_b32 s70, s93, 7
    s_mul_i32 s71, s93, 196608
    s_add_u32 s70, s70, s94
    s_add_u32 s71, s71, s95
    s_add_u32 m0, s73, 86016
    s_nop 0
    buffer_load_dwordx4 v2, s[4:7], s70 offen lds
    s_add_u32 m0, s73, 87040
    s_nop 0
    buffer_load_dwordx4 v3, s[4:7], s70 offen lds
    ds_read_b128 a[8:11], v12
    ds_read_b64_tr_b16 v[20:21], v16 offset:6144
    ds_read_b64_tr_b16 v[22:23], v16 offset:6912
    ds_read_b64_tr_b16 v[24:25], v16 offset:6208
    ds_read_b64_tr_b16 v[26:27], v16 offset:6976
    s_waitcnt lgkmcnt(5)
    v_mfma_f32_32x32x16_bf16 v[44:59], v[32:35], a[4:7], v[44:59]
    v_mfma_f32_32x32x16_bf16 v[60:75], v[36:39], a[4:7], v[60:75]
    s_add_u32 m0, s74, 86016
    s_nop 0
    buffer_load_dwordx4 v4, s[8:11], s71 offen lds
    s_add_u32 s93, s92, 4
    s_and_b32 s93, s93, 7
    s_lshl_b32 s70, s93, 7
    s_mul_i32 s71, s93, 196608
    s_add_u32 s70, s70, s94
    s_add_u32 s71, s71, s95
    s_add_u32 m0, s73, 114688
    s_nop 0
    buffer_load_dwordx4 v2, s[4:7], s70 offen lds
    ds_read_b128 a[12:15], v13
    ds_read_b64_tr_b16 v[32:33], v16 offset:9216
    ds_read_b64_tr_b16 v[34:35], v16 offset:9984
    ds_read_b64_tr_b16 v[36:37], v16 offset:9280
    ds_read_b64_tr_b16 v[38:39], v16 offset:10048
    s_waitcnt lgkmcnt(5)
    v_mfma_f32_32x32x16_bf16 v[44:59], v[20:23], a[8:11], v[44:59]
    v_mfma_f32_32x32x16_bf16 v[60:75], v[24:27], a[8:11], v[60:75]
    s_add_u32 m0, s73, 115712
    s_nop 0
    buffer_load_dwordx4 v3, s[4:7], s70 offen lds
    s_add_u32 m0, s74, 114688
    s_nop 0
    buffer_load_dwordx4 v4, s[8:11], s71 offen lds
    s_waitcnt vmcnt(10) lgkmcnt(0)
    s_barrier
    v_add_u32 v10, 28672, v9
    v_xor_b32 v11, 32, v10
    v_xor_b32 v12, 64, v10
    v_xor_b32 v13, 96, v10
    v_add_u32 v16, 28672, v14
    ds_read_b128 a[16:19], v10
    ds_read_b64_tr_b16 v[20:21], v16 offset:0
    ds_read_b64_tr_b16 v[22:23], v16 offset:768
    ds_read_b64_tr_b16 v[24:25], v16 offset:64
    ds_read_b64_tr_b16 v[26:27], v16 offset:832
    v_mfma_f32_32x32x16_bf16 v[44:59], v[32:35], a[12:15], v[44:59]
    v_mfma_f32_32x32x16_bf16 v[60:75], v[36:39], a[12:15], v[60:75]
    s_add_u32 s93, s92, 5
    s_and_b32 s93, s93, 7
    s_lshl_b32 s70, s93, 7
    s_mul_i32 s71, s93, 196608
    s_add_u32 s70, s70, s94
    s_add_u32 s71, s71, s95
    s_add_u32 m0, s73, 0
    s_nop 0
    buffer_load_dwordx4 v2, s[4:7], s70 offen lds
    ds_read_b128 a[20:23], v11
    ds_read_b64_tr_b16 v[32:33], v16 offset:3072
    ds_read_b64_tr_b16 v[34:35], v16 offset:3840
    ds_read_b64_tr_b16 v[36:37], v16 offset:3136
    ds_read_b64_tr_b16 v[38:39], v16 offset:3904
    s_waitcnt lgkmcnt(5)
    v_mfma_f32_32x32x16_bf16 v[44:59], v[20:23], a[16:19], v[44:59]
    v_mfma_f32_32x32x16_bf16 v[60:75], v[24:27], a[16:19], v[60:75]
    s_add_u32 m0, s73, 1024
    s_nop 0
    buffer_load_dwordx4 v3, s[4:7], s70 offen lds
    ds_read_b128 a[24:27], v12
    ds_read_b64_tr_b16 v[20:21], v16 offset:6144
    ds_read_b64_tr_b16 v[22:23], v16 offset:6912
    ds_read_b64_tr_b16 v[24:25], v16 offset:6208
    ds_read_b64_tr_b16 v[26:27], v16 offset:6976
    s_waitcnt lgkmcnt(5)
    v_mfma_f32_32x32x16_bf16 v[44:59], v[32:35], a[20:23], v[44:59]
    v_mfma_f32_32x32x16_bf16 v[60:75], v[36:39], a[20:23], v[60:75]
    s_add_u32 m0, s74, 0
    s_nop 0
    buffer_load_dwordx4 v4, s[8:11], s71 offen lds
    ds_read_b128 a[28:31], v13
    ds_read_b64_tr_b16 v[32:33], v16 offset:9216
    ds_read_b64_tr_b16 v[34:35], v16 offset:9984
    ds_read_b64_tr_b16 v[36:37], v16 offset:9280
    ds_read_b64_tr_b16 v[38:39], v16 offset:10048
    s_waitcnt lgkmcnt(5)
    v_mfma_f32_32x32x16_bf16 v[44:59], v[20:23], a[24:27], v[44:59]
    v_mfma_f32_32x32x16_bf16 v[60:75], v[24:27], a[24:27], v[60:75]
    s_waitcnt vmcnt(9) lgkmcnt(0)
    s_barrier
    s_cmp_lg_u32 s3, 0
    s_cbranch_scc1 L_rs_4
    s_cmp_ge_u32 s2, 2
    s_cbranch_scc1 L_rs_4
    v_mov_b32 v124, s2
    v_mov_b32 v125, 1
    s_mov_b64 exec, 1
    buffer_store_byte v125, v124, s[32:35], 0 offen sc1
    s_mov_b64 exec, -1
L_rs_4:
    v_add_u32 v10, 57344, v9
    v_xor_b32 v11, 32, v10
    v_xor_b32 v12, 64, v10
    v_xor_b32 v13, 96, v10
    v_add_u32 v16, 57344, v14
    ds_read_b128 a[32:35], v10
    ds_read_b64_tr_b16 v[20:21], v16 offset:0
    ds_read_b64_tr_b16 v[22:23], v16 offset:768
    ds_read_b64_tr_b16 v[24:25], v16 offset:64
    ds_read_b64_tr_b16 v[26:27], v16 offset:832
    v_mfma_f32_32x32x16_bf16 v[44:59], v[32:35], a[28:31], v[44:59]
    v_mfma_f32_32x32x16_bf16 v[60:75], v[36:39], a[28:31], v[60:75]
    s_add_u32 s93, s92, 6
    s_and_b32 s93, s93, 7
    s_lshl_b32 s70, s93, 7
    s_mul_i32 s71, s93, 196608
    s_add_u32 s70, s70, s94
    s_add_u32 s71, s71, s95
    s_add_u32 m0, s73, 28672
    s_nop 0
    buffer_load_dwordx4 v2, s[4:7], s70 offen lds
    ds_read_b128 a[36:39], v11
    ds_read_b64_tr_b16 v[32:33], v16 offset:3072
    ds_read_b64_tr_b16 v[34:35], v16 offset:3840
    ds_read_b64_tr_b16 v[36:37], v16 offset:3136
    ds_read_b64_tr_b16 v[38:39], v16 offset:3904
    s_waitcnt lgkmcnt(5)
    v_mfma_f32_32x32x16_bf16 v[44:59], v[20:23], a[32:35], v[44:59]
    v_mfma_f32_32x32x16_bf16 v[60:75], v[24:27], a[32:35], v[60:75]
    s_add_u32 m0, s73, 29696
    s_nop 0
    buffer_load_dwordx4 v3, s[4:7], s70 offen lds
    ds_read_b128 a[40:43], v12
    ds_read_b64_tr_b16 v[20:21], v16 offset:6144
    ds_read_b64_tr_b16 v[22:23], v16 offset:6912
    ds_read_b64_tr_b16 v[24:25], v16 offset:6208
    ds_read_b64_tr_b16 v[26:27], v16 offset:6976
    s_waitcnt lgkmcnt(5)
    v_mfma_f32_32x32x16_bf16 v[44:59], v[32:35], a[36:39], v[44:59]
    v_mfma_f32_32x32x16_bf16 v[60:75], v[36:39], a[36:39], v[60:75]
    s_add_u32 m0, s74, 28672
    s_nop 0
    buffer_load_dwordx4 v4, s[8:11], s71 offen lds
    ds_read_b128 a[44:47], v13
    ds_read_b64_tr_b16 v[32:33], v16 offset:9216
    ds_read_b64_tr_b16 v[34:35], v16 offset:9984
    ds_read_b64_tr_b16 v[36:37], v16 offset:9280
    ds_read_b64_tr_b16 v[38:39], v16 offset:10048
    s_waitcnt lgkmcnt(5)
    v_mfma_f32_32x32x16_bf16 v[44:59], v[20:23], a[40:43], v[44:59]
    v_mfma_f32_32x32x16_bf16 v[60:75], v[24:27], a[40:43], v[60:75]
    s_waitcnt vmcnt(9) lgkmcnt(0)
    s_barrier
    v_add_u32 v10, 86016, v9
    v_xor_b32 v11, 32, v10
    v_xor_b32 v12, 64, v10
    v_xor_b32 v13, 96, v10
    v_add_u32 v16, 86016, v14
    ds_read_b128 a[48:51], v10
    ds_read_b64_tr_b16 v[20:21], v16 offset:0
    ds_read_b64_tr_b16 v[22:23], v16 offset:768
    ds_read_b64_tr_b16 v[24:25], v16 offset:64
    ds_read_b64_tr_b16 v[26:27], v16 offset:832
    v_mfma_f32_32x32x16_bf16 v[44:59], v[32:35], a[44:47], v[44:59]
    v_mfma_f32_32x32x16_bf16 v[60:75], v[36:39], a[44:47], v[60:75]
    s_add_u32 s93, s92, 7
    s_and_b32 s93, s93, 7
    s_lshl_b32 s70, s93, 7
    s_mul_i32 s71, s93, 196608
    s_add_u32 s70, s70, s94
    s_add_u32 s71, s71, s95
    s_add_u32 m0, s73, 57344
    s_nop 0
    buffer_load_dwordx4 v2, s[4:7], s70 offen lds
    ds_read_b128 a[52:55], v11
    ds_read_b64_tr_b16 v[32:33], v16 offset:3072
    ds_read_b64_tr_b16 v[34:35], v16 offset:3840
    ds_read_b64_tr_b16 v[36:37], v16 offset:3136
    ds_read_b64_tr_b16 v[38:39], v16 offset:3904
    s_waitcnt lgkmcnt(5)
    v_mfma_f32_32x32x16_bf16 v[44:59], v[20:23], a[48:51], v[44:59]
    v_mfma_f32_32x32x16_bf16 v[60:75], v[24:27], a[48:51], v[60:75]
    s_add_u32 m0, s73, 58368
    s_nop 0
    buffer_load_dwordx4 v3, s[4:7], s70 offen lds
    ds_read_b128 a[56:59], v12
    ds_read_b64_tr_b16 v[20:21], v16 offset:6144
    ds_read_b64_tr_b16 v[22:23], v16 offset:6912
    ds_read_b64_tr_b16 v[24:25], v16 offset:6208
    ds_read_b64_tr_b16 v[26:27], v16 offset:6976
    s_waitcnt lgkmcnt(5)
    v_mfma_f32_32x32x16_bf16 v[44:59], v[32:35], a[52:55], v[44:59]
    v_mfma_f32_32x32x16_bf16 v[60:75], v[36:39], a[52:55], v[60:75]
    s_add_u32 m0, s74, 57344
    s_nop 0
    buffer_load_dwordx4 v4, s[8:11], s71 offen lds
    ds_read_b128 a[60:63], v13
    ds_read_b64_tr_b16 v[32:33], v16 offset:9216
    ds_read_b64_tr_b16 v[34:35], v16 offset:9984
    ds_read_b64_tr_b16 v[36:37], v16 offset:9280
    ds_read_b64_tr_b16 v[38:39], v16 offset:10048
    s_waitcnt lgkmcnt(5)
    v_mfma_f32_32x32x16_bf16 v[44:59], v[20:23], a[56:59], v[44:59]
    v_mfma_f32_32x32x16_bf16 v[60:75], v[24:27], a[56:59], v[60:75]
    s_waitcnt vmcnt(9) lgkmcnt(0)
    s_barrier
    v_add_u32 v10, 114688, v9
    v_xor_b32 v11, 32, v10
    v_xor_b32 v12, 64, v10
    v_xor_b32 v13, 96, v10
    v_add_u32 v16, 114688, v14
    ds_read_b128 a[64:67], v10
    ds_read_b64_tr_b16 v[20:21], v16 offset:0
    ds_read_b64_tr_b16 v[22:23], v16 offset:768
    ds_read_b64_tr_b16 v[24:25], v16 offset:64
    ds_read_b64_tr_b16 v[26:27], v16 offset:832
    v_mfma_f32_32x32x16_bf16 v[44:59], v[32:35], a[60:63], v[44:59]
    v_mfma_f32_32x32x16_bf16 v[60:75], v[36:39], a[60:63], v[60:75]
    s_add_u32 s93, s92, 0
    s_and_b32 s93, s93, 7
    s_mul_i32 s72, s93, 176128
    s_add_u32 s72, s72, s96
    s_add_u32 m0, s75, 86016
    s_nop 0
    buffer_load_dwordx4 v6, s[12:15], s72 offen lds
    ds_read_b128 a[68:71], v11
    ds_read_b64_tr_b16 v[32:33], v16 offset:3072
    ds_read_b64_tr_b16 v[34:35], v16 offset:3840
    ds_read_b64_tr_b16 v[36:37], v16 offset:3136
    ds_read_b64_tr_b16 v[38:39], v16 offset:3904
    s_waitcnt lgkmcnt(5)
    v_mfma_f32_32x32x16_bf16 v[44:59], v[20:23], a[64:67], v[44:59]
    v_mfma_f32_32x32x16_bf16 v[60:75], v[24:27], a[64:67], v[60:75]
    s_add_u32 m0, s75, 87040
    s_nop 0
    buffer_load_dwordx4 v7, s[12:15], s72 offen lds
    ds_read_b128 a[72:75], v12
    ds_read_b64_tr_b16 v[20:21], v16 offset:6144
    ds_read_b64_tr_b16 v[22:23], v16 offset:6912
    ds_read_b64_tr_b16 v[24:25], v16 offset:6208
    ds_read_b64_tr_b16 v[26:27], v16 offset:6976
    s_waitcnt lgkmcnt(5)
    v_mfma_f32_32x32x16_bf16 v[44:59], v[32:35], a[68:71], v[44:59]
    v_mfma_f32_32x32x16_bf16 v[60:75], v[36:39], a[68:71], v[60:75]
    s_add_u32 m0, s75, 88064
    s_nop 0
    buffer_load_dwordx4 v8, s[12:15], s72 offen lds
    ds_read_b128 a[76:79], v13
    ds_read_b64_tr_b16 v[32:33], v16 offset:9216
    ds_read_b64_tr_b16 v[34:35], v16 offset:9984
    ds_read_b64_tr_b16 v[36:37], v16 offset:9280
    ds_read_b64_tr_b16 v[38:39], v16 offset:10048
    s_waitcnt lgkmcnt(5)
    v_mfma_f32_32x32x16_bf16 v[44:59], v[20:23], a[72:75], v[44:59]
    v_mfma_f32_32x32x16_bf16 v[60:75], v[24:27], a[72:75], v[60:75]
    s_waitcnt vmcnt(9) lgkmcnt(0)
    s_barrier
    v_mov_b32 v125, 0x101
    s_cmp_eq_u32 s3, 0
    s_cselect_b64 exec, -1, 0
    buffer_load_dword v125, v126, s[32:35], 0 offen sc1
    s_mov_b64 exec, -1
    v_add_u32 v10, 0, v9
    v_xor_b32 v11, 32, v10
    v_xor_b32 v12, 64, v10
    v_xor_b32 v13, 96, v10
    v_add_u32 v16, 0, v14
    ds_read_b128 a[80:83], v10
    ds_read_b64_tr_b16 v[20:21], v16 offset:0
    ds_read_b64_tr_b16 v[22:23], v16 offset:768
    ds_read_b64_tr_b16 v[24:25], v16 offset:64
    ds_read_b64_tr_b16 v[26:27], v16 offset:832
    v_mfma_f32_32x32x16_bf16 v[44:59], v[32:35], a[76:79], v[44:59]
    v_mfma_f32_32x32x16_bf16 v[60:75], v[36:39], a[76:79], v[60:75]
    s_add_u32 s93, s92, 1
    s_and_b32 s93, s93, 7
    s_mul_i32 s72, s93, 176128
    s_add_u32 s72, s72, s96
    s_add_u32 m0, s75, 114688
    s_nop 0
    buffer_load_dwordx4 v6, s[12:15], s72 offen lds
    ds_read_b128 a[84:87], v11
    ds_read_b64_tr_b16 v[32:33], v16 offset:3072
    ds_read_b64_tr_b16 v[34:35], v16 offset:3840
    ds_read_b64_tr_b16 v[36:37], v16 offset:3136
    ds_read_b64_tr_b16 v[38:39], v16 offset:3904
    s_waitcnt lgkmcnt(5)
    v_mfma_f32_32x32x16_bf16 v[44:59], v[20:23], a[80:83], v[44:59]
    v_mfma_f32_32x32x16_bf16 v[60:75], v[24:27], a[80:83], v[60:75]
    s_add_u32 m0, s75, 115712
    s_nop 0
    buffer_load_dwordx4 v7, s[12:15], s72 offen lds
    ds_read_b128 a[88:91], v12
    ds_read_b64_tr_b16 v[20:21], v16 offset:6144
    ds_read_b64_tr_b16 v[22:23], v16 offset:6912
    ds_read_b64_tr_b16 v[24:25], v16 offset:6208
    ds_read_b64_tr_b16 v[26:27], v16 offset:6976
    s_waitcnt lgkmcnt(5)
    v_mfma_f32_32x32x16_bf16 v[44:59], v[32:35], a[84:87], v[44:59]
    v_mfma_f32_32x32x16_bf16 v[60:75], v[36:39], a[84:87], v[60:75]
    s_add_u32 m0, s75, 116736
    s_nop 0
    buffer_load_dwordx4 v8, s[12:15], s72 offen lds
    ds_read_b128 a[92:95], v13
    ds_read_b64_tr_b16 v[32:33], v16 offset:9216
    ds_read_b64_tr_b16 v[34:35], v16 offset:9984
    ds_read_b64_tr_b16 v[36:37], v16 offset:9280
    ds_read_b64_tr_b16 v[38:39], v16 offset:10048
    s_waitcnt lgkmcnt(5)
    v_mfma_f32_32x32x16_bf16 v[44:59], v[20:23], a[88:91], v[44:59]
    v_mfma_f32_32x32x16_bf16 v[60:75], v[24:27], a[88:91], v[60:75]
    s_waitcnt vmcnt(9) lgkmcnt(0)
    s_barrier
    v_add_u32 v10, 28672, v9
    v_xor_b32 v11, 32, v10
    v_xor_b32 v12, 64, v10
    v_xor_b32 v13, 96, v10
    v_add_u32 v16, 28672, v14
    ds_read_b128 a[96:99], v10
    ds_read_b64_tr_b16 v[20:21], v16 offset:0
    ds_read_b64_tr_b16 v[22:23], v16 offset:768
    ds_read_b64_tr_b16 v[24:25], v16 offset:64
    ds_read_b64_tr_b16 v[26:27], v16 offset:832
    v_mfma_f32_32x32x16_bf16 v[44:59], v[32:35], a[92:95], v[44:59]
    v_mfma_f32_32x32x16_bf16 v[60:75], v[36:39], a[92:95], v[60:75]
    s_add_u32 s93, s92, 2
    s_and_b32 s93, s93, 7
    s_mul_i32 s72, s93, 176128
    s_add_u32 s72, s72, s96
    s_add_u32 m0, s75, 0
    s_nop 0
    buffer_load_dwordx4 v6, s[12:15], s72 offen lds
    ds_read_b128 a[100:103], v11
    ds_read_b64_tr_b16 v[32:33], v16 offset:3072
    ds_read_b64_tr_b16 v[34:35], v16 offset:3840
    ds_read_b64_tr_b16 v[36:37], v16 offset:3136
    ds_read_b64_tr_b16 v[38:39], v16 offset:3904
    s_waitcnt lgkmcnt(5)
    v_mfma_f32_32x32x16_bf16 v[44:59], v[20:23], a[96:99], v[44:59]
    v_mfma_f32_32x32x16_bf16 v[60:75], v[24:27], a[96:99], v[60:75]
    s_add_u32 m0, s75, 1024
    s_nop 0
    buffer_load_dwordx4 v7, s[12:15], s72 offen lds
    ds_read_b128 a[104:107], v12
    ds_read_b64_tr_b16 v[20:21], v16 offset:6144
    ds_read_b64_tr_b16 v[22:23], v16 offset:6912
    ds_read_b64_tr_b16 v[24:25], v16 offset:6208
    ds_read_b64_tr_b16 v[26:27], v16 offset:6976
    s_waitcnt lgkmcnt(5)
    v_mfma_f32_32x32x16_bf16 v[44:59], v[32:35], a[100:103], v[44:59]
    v_mfma_f32_32x32x16_bf16 v[60:75], v[36:39], a[100:103], v[60:75]
    s_add_u32 m0, s75, 2048
    s_nop 0
    buffer_load_dwordx4 v8, s[12:15], s72 offen lds
    ds_read_b128 a[108:111], v13
    ds_read_b64_tr_b16 v[32:33], v16 offset:9216
    ds_read_b64_tr_b16 v[34:35], v16 offset:9984
    ds_read_b64_tr_b16 v[36:37], v16 offset:9280
    ds_read_b64_tr_b16 v[38:39], v16 offset:10048
    s_waitcnt lgkmcnt(5)
    v_mfma_f32_32x32x16_bf16 v[44:59], v[20:23], a[104:107], v[44:59]
    v_mfma_f32_32x32x16_bf16 v[60:75], v[24:27], a[104:107], v[60:75]
    s_waitcnt vmcnt(9) lgkmcnt(0)
    s_barrier
    v_add_u32 v10, 57344, v9
    v_xor_b32 v11, 32, v10
    v_xor_b32 v12, 64, v10
    v_xor_b32 v13, 96, v10
    v_add_u32 v16, 57344, v14
    ds_read_b128 a[112:115], v10
    ds_read_b64_tr_b16 v[20:21], v16 offset:0
    ds_read_b64_tr_b16 v[22:23], v16 offset:768
    ds_read_b64_tr_b16 v[24:25], v16 offset:64
    ds_read_b64_tr_b16 v[26:27], v16 offset:832
    v_mfma_f32_32x32x16_bf16 v[44:59], v[32:35], a[108:111], v[44:59]
    v_mfma_f32_32x32x16_bf16 v[60:75], v[36:39], a[108:111], v[60:75]
    s_add_u32 s93, s92, 3
    s_and_b32 s93, s93, 7
    s_mul_i32 s72, s93, 176128
    s_add_u32 s72, s72, s96
    s_add_u32 m0, s75, 28672
    s_nop 0
    buffer_load_dwordx4 v6, s[12:15], s72 offen lds
    ds_read_b128 a[116:119], v11
    ds_read_b64_tr_b16 v[32:33], v16 offset:3072
    ds_read_b64_tr_b16 v[34:35], v16 offset:3840
    ds_read_b64_tr_b16 v[36:37], v16 offset:3136
    ds_read_b64_tr_b16 v[38:39], v16 offset:3904
    s_waitcnt lgkmcnt(5)
    v_mfma_f32_32x32x16_bf16 v[44:59], v[20:23], a[112:115], v[44:59]
    v_mfma_f32_32x32x16_bf16 v[60:75], v[24:27], a[112:115], v[60:75]
    s_add_u32 m0, s75, 29696
    s_nop 0
    buffer_load_dwordx4 v7, s[12:15], s72 offen lds
    ds_read_b128 a[120:123], v12
    ds_read_b64_tr_b16 v[20:21], v16 offset:6144
    ds_read_b64_tr_b16 v[22:23], v16 offset:6912
    ds_read_b64_tr_b16 v[24:25], v16 offset:6208
    ds_read_b64_tr_b16 v[26:27], v16 offset:6976
    s_waitcnt lgkmcnt(5)
    v_mfma_f32_32x32x16_bf16 v[44:59], v[32:35], a[116:119], v[44:59]
    v_mfma_f32_32x32x16_bf16 v[60:75], v[36:39], a[116:119], v[60:75]
    s_add_u32 m0, s75, 30720
    s_nop 0
    buffer_load_dwordx4 v8, s[12:15], s72 offen lds
    ds_read_b128 a[124:127], v13
    ds_read_b64_tr_b16 v[32:33], v16 offset:9216
    ds_read_b64_tr_b16 v[34:35], v16 offset:9984
    ds_read_b64_tr_b16 v[36:37], v16 offset:9280
    ds_read_b64_tr_b16 v[38:39], v16 offset:10048
    s_waitcnt lgkmcnt(5)
    v_mfma_f32_32x32x16_bf16 v[44:59], v[20:23], a[120:123], v[44:59]
    v_mfma_f32_32x32x16_bf16 v[60:75], v[24:27], a[120:123], v[60:75]
    s_waitcnt vmcnt(9) lgkmcnt(0)
    s_cmp_lg_u32 s3, 0
    s_cbranch_scc1 L_pd_5
    s_mov_b32 s80, 400000
    s_waitcnt vmcnt(9)
L_pl_6:
    v_cmp_ne_u32 vcc, 0x101, v125
    s_nop 4
    s_cbranch_vccz L_pd_5
    s_sub_u32 s80, s80, 1
    s_cmp_eq_u32 s80, 0
    s_cbranch_scc1 L_pd_5
    buffer_load_dword v125, v126, s[32:35], 0 offen sc1
    s_waitcnt vmcnt(0)
    s_branch L_pl_6
L_pd_5:
    s_barrier
    v_add_u32 v16, 86016, v18
    ds_read_b64_tr_b16 v[20:21], v16 offset:0
    ds_read_b64_tr_b16 v[22:23], v16 offset:768
    ds_read_b64_tr_b16 v[24:25], v16 offset:32
    ds_read_b64_tr_b16 v[26:27], v16 offset:800
    ds_read_b64_tr_b16 v[28:29], v16 offset:64
    ds_read_b64_tr_b16 v[30:31], v16 offset:832
    v_mfma_f32_32x32x16_bf16 v[44:59], v[32:35], a[124:127], v[44:59]
    v_mfma_f32_32x32x16_bf16 v[60:75], v[36:39], a[124:127], v[60:75]
    s_add_u32 s93, s92, 4
    s_and_b32 s93, s93, 7
    s_mul_i32 s72, s93, 176128
    s_add_u32 s72, s72, s96
    s_add_u32 m0, s75, 57344
    s_nop 0
    buffer_load_dwordx4 v6, s[12:15], s72 offen lds
    ds_read_b64_tr_b16 v[32:33], v16 offset:3072
    ds_read_b64_tr_b16 v[34:35], v16 offset:3840
    ds_read_b64_tr_b16 v[36:37], v16 offset:3104
    ds_read_b64_tr_b16 v[38:39], v16 offset:3872
    ds_read_b64_tr_b16 v[40:41], v16 offset:3136
    ds_read_b64_tr_b16 v[42:43], v16 offset:3904
    s_waitcnt lgkmcnt(6)
    v_mfma_f32_32x32x16_bf16 v[76:91], v[20:23], a[0:3], 0
    v_mfma_f32_32x32x16_bf16 v[92:107], v[24:27], a[0:3], 0
    s_mul_i32 s97, s43, 3
    s_lshl_b32 s98, s42, 2
    s_and_b32 s99, s3, 3
    s_add_u32 s98, s98, s99
    s_lshl_b32 s98, s98, 10
    s_lshl_b32 s99, s97, 17
    s_add_u32 s99, s99, s98
    s_cmp_lt_u32 s97, 16
    s_cselect_b32 s100, 0x3eb8aa3b, 1.0
    s_cselect_b64 vcc, -1, 0
    v_cndmask_b32 v10, v19, v1, vcc
    v_mul_f32 v44, s100, v44
    v_mul_f32 v45, s100, v45
    v_mul_f32 v46, s100, v46
    v_mul_f32 v47, s100, v47
    v_mul_f32 v48, s100, v48
    v_mul_f32 v49, s100, v49
    v_mul_f32 v50, s100, v50
    v_mul_f32 v51, s100, v51
    v_cvt_pk_bf16_f32 v44, v44, v45
    v_mfma_f32_32x32x16_bf16 v[108:123], v[28:31], a[0:3], 0
    v_cvt_pk_bf16_f32 v45, v46, v47
    v_cvt_pk_bf16_f32 v46, v48, v49
    v_cvt_pk_bf16_f32 v47, v50, v51
    buffer_store_dwordx4 v[44:47], v10, s[24:27], s99 offen sc1
    v_mul_f32 v52, s100, v52
    v_mul_f32 v53, s100, v53
    v_mul_f32 v54, s100, v54
    v_mul_f32 v55, s100, v55
    v_mul_f32 v56, s100, v56
    v_mul_f32 v57, s100, v57
    v_mul_f32 v58, s100, v58
    v_mul_f32 v59, s100, v59
    s_add_u32 m0, s75, 58368
    s_nop 0
    buffer_load_dwordx4 v7, s[12:15], s72 offen lds
    ds_read_b64_tr_b16 v[20:21], v16 offset:6144
    ds_read_b64_tr_b16 v[22:23], v16 offset:6912
    ds_read_b64_tr_b16 v[24:25], v16 offset:6176
    ds_read_b64_tr_b16 v[26:27], v16 offset:6944
    ds_read_b64_tr_b16 v[28:29], v16 offset:6208
    ds_read_b64_tr_b16 v[30:31], v16 offset:6976
    s_waitcnt lgkmcnt(6)
    v_mfma_f32_32x32x16_bf16 v[76:91], v[32:35], a[4:7], v[76:91]
    v_cvt_pk_bf16_f32 v48, v52, v53
    v_cvt_pk_bf16_f32 v49, v54, v55
    v_cvt_pk_bf16_f32 v50, v56, v57
    v_cvt_pk_bf16_f32 v51, v58, v59
    s_add_u32 s99, s99, 65536
    buffer_store_dwordx4 v[48:51], v10, s[24:27], s99 offen sc1
    s_add_u32 s97, s97, 1
    s_lshl_b32 s99, s97, 17
    s_add_u32 s99, s99, s98
    s_cmp_lt_u32 s97, 16
    s_cselect_b32 s100, 0x3eb8aa3b, 1.0
    s_cselect_b64 vcc, -1, 0
    v_cndmask_b32 v10, v19, v1, vcc
    v_mul_f32 v60, s100, v60
    v_mul_f32 v61, s100, v61
    v_mul_f32 v62, s100, v62
    v_mul_f32 v63, s100, v63
    v_mfma_f32_32x32x16_bf16 v[92:107], v[36:39], a[4:7], v[92:107]
    v_mul_f32 v64, s100, v64
    v_mul_f32 v65, s100, v65
    v_mul_f32 v66, s100, v66
    v_mul_f32 v67, s100, v67
    v_cvt_pk_bf16_f32 v60, v60, v61
    v_cvt_pk_bf16_f32 v61, v62, v63
    v_cvt_pk_bf16_f32 v62, v64, v65
    v_cvt_pk_bf16_f32 v63, v66, v67
    buffer_store_dwordx4 v[60:63], v10, s[24:27], s99 offen sc1
    v_mul_f32 v68, s100, v68
    v_mul_f32 v69, s100, v69
    v_mfma_f32_32x32x16_bf16 v[108:123], v[40:43], a[4:7], v[108:123]
    v_mul_f32 v70, s100, v70
    v_mul_f32 v71, s100, v71
    v_mul_f32 v72, s100, v72
    v_mul_f32 v73, s100, v73
    v_mul_f32 v74, s100, v74
    v_mul_f32 v75, s100, v75
    v_cvt_pk_bf16_f32 v64, v68, v69
    v_cvt_pk_bf16_f32 v65, v70, v71
    v_cvt_pk_bf16_f32 v66, v72, v73
    v_cvt_pk_bf16_f32 v67, v74, v75
    s_add_u32 s99, s99, 65536
    buffer_store_dwordx4 v[64:67], v10, s[24:27], s99 offen sc1
    s_add_u32 m0, s75, 59392
    s_nop 0
    buffer_load_dwordx4 v8, s[12:15], s72 offen lds
    ds_read_b64_tr_b16 v[32:33], v16 offset:9216
    ds_read_b64_tr_b16 v[34:35], v16 offset:9984
    ds_read_b64_tr_b16 v[36:37], v16 offset:9248
    ds_read_b64_tr_b16 v[38:39], v16 offset:10016
    ds_read_b64_tr_b16 v[40:41], v16 offset:9280
    ds_read_b64_tr_b16 v[42:43], v16 offset:10048
    s_waitcnt lgkmcnt(6)
    v_mfma_f32_32x32x16_bf16 v[76:91], v[20:23], a[8:11], v[76:91]
    v_mfma_f32_32x32x16_bf16 v[92:107], v[24:27], a[8:11], v[92:107]
    v_mfma_f32_32x32x16_bf16 v[108:123], v[28:31], a[8:11], v[108:123]
    s_branch L_B1
L_A0V:
    s_waitcnt vmcnt(4)
    s_barrier
    v_add_u32 v10, 0, v9
    v_xor_b32 v11, 32, v10
    v_xor_b32 v12, 64, v10
    v_xor_b32 v13, 96, v10
    v_add_u32 v16, 0, v14
    ds_read_b128 a[0:3], v10
    ds_read_b64_tr_b16 v[20:21], v16 offset:0
    ds_read_b64_tr_b16 v[22:23], v16 offset:768
    ds_read_b64_tr_b16 v[24:25], v16 offset:64
    ds_read_b64_tr_b16 v[26:27], v16 offset:832
    s_add_u32 s93, s92, 2
    s_and_b32 s93, s93, 7
    s_lshl_b32 s70, s93, 7
    s_mul_i32 s71, s93, 196608
    s_add_u32 s70, s70, s94
    s_add_u32 s71, s71, s95
    s_add_u32 m0, s73, 57344
    s_nop 0
    buffer_load_dwordx4 v2, s[4:7], s70 offen lds
    s_add_u32 m0, s73, 58368
    s_nop 0
    buffer_load_dwordx4 v3, s[4:7], s70 offen lds
    s_add_u32 m0, s74, 57344
    s_nop 0
    buffer_load_dwordx4 v4, s[8:11], s71 offen lds
    ds_read_b128 a[4:7], v11
    ds_read_b64_tr_b16 v[32:33], v16 offset:3072
    ds_read_b64_tr_b16 v[34:35], v16 offset:3840
    ds_read_b64_tr_b16 v[36:37], v16 offset:3136
    ds_read_b64_tr_b16 v[38:39], v16 offset:3904
    s_waitcnt lgkmcnt(5)
    v_mfma_f32_32x32x16_bf16 v[44:59], a[0:3], v[20:23], 0
    v_mfma_f32_32x32x16_bf16 v[60:75], a[0:3], v[24:27], 0
    s_add_u32 s93, s92, 3
    s_and_b32 s93, s93, 7
    s_lshl_b32 s70, s93, 7
    s_mul_i32 s71, s93, 196608
    s_add_u32 s70, s70, s94
    s_add_u32 s71, s71, s95
    s_add_u32 m0, s73, 86016
    s_nop 0
    buffer_load_dwordx4 v2, s[4:7], s70 offen lds
    s_add_u32 m0, s73, 87040
    s_nop 0
    buffer_load_dwordx4 v3, s[4:7], s70 offen lds
    ds_read_b128 a[8:11], v12
    ds_read_b64_tr_b16 v[20:21], v16 offset:6144
    ds_read_b64_tr_b16 v[22:23], v16 offset:6912
    ds_read_b64_tr_b16 v[24:25], v16 offset:6208
    ds_read_b64_tr_b16 v[26:27], v16 offset:6976
    s_waitcnt lgkmcnt(5)
    v_mfma_f32_32x32x16_bf16 v[44:59], a[4:7], v[32:35], v[44:59]
    v_mfma_f32_32x32x16_bf16 v[60:75], a[4:7], v[36:39], v[60:75]
    s_add_u32 m0, s74, 86016
    s_nop 0
    buffer_load_dwordx4 v4, s[8:11], s71 offen lds
    s_add_u32 s93, s92, 4
    s_and_b32 s93, s93, 7
    s_lshl_b32 s70, s93, 7
    s_mul_i32 s71, s93, 196608
    s_add_u32 s70, s70, s94
    s_add_u32 s71, s71, s95
    s_add_u32 m0, s73, 114688
    s_nop 0
    buffer_load_dwordx4 v2, s[4:7], s70 offen lds
    ds_read_b128 a[12:15], v13
    ds_read_b64_tr_b16 v[32:33], v16 offset:9216
    ds_read_b64_tr_b16 v[34:35], v16 offset:9984
    ds_read_b64_tr_b16 v[36:37], v16 offset:9280
    ds_read_b64_tr_b16 v[38:39], v16 offset:10048
    s_waitcnt lgkmcnt(5)
    v_mfma_f32_32x32x16_bf16 v[44:59], a[8:11], v[20:23], v[44:59]
    v_mfma_f32_32x32x16_bf16 v[60:75], a[8:11], v[24:27], v[60:75]
    s_add_u32 m0, s73, 115712
    s_nop 0
    buffer_load_dwordx4 v3, s[4:7], s70 offen lds
    s_add_u32 m0, s74, 114688
    s_nop 0
    buffer_load_dwordx4 v4, s[8:11], s71 offen lds
    s_waitcnt vmcnt(10) lgkmcnt(0)
    s_barrier
    v_add_u32 v10, 28672, v9
    v_xor_b32 v11, 32, v10
    v_xor_b32 v12, 64, v10
    v_xor_b32 v13, 96, v10
    v_add_u32 v16, 28672, v14
    ds_read_b128 a[16:19], v10
    ds_read_b64_tr_b16 v[20:21], v16 offset:0
    ds_read_b64_tr_b16 v[22:23], v16 offset:768
    ds_read_b64_tr_b16 v[24:25], v16 offset:64
    ds_read_b64_tr_b16 v[26:27], v16 offset:832
    v_mfma_f32_32x32x16_bf16 v[44:59], a[12:15], v[32:35], v[44:59]
    v_mfma_f32_32x32x16_bf16 v[60:75], a[12:15], v[36:39], v[60:75]
    s_add_u32 s93, s92, 5
    s_and_b32 s93, s93, 7
    s_lshl_b32 s70, s93, 7
    s_mul_i32 s71, s93, 196608
    s_add_u32 s70, s70, s94
    s_add_u32 s71, s71, s95
    s_add_u32 m0, s73, 0
    s_nop 0
    buffer_load_dwordx4 v2, s[4:7], s70 offen lds
    ds_read_b128 a[20:23], v11
    ds_read_b64_tr_b16 v[32:33], v16 offset:3072
    ds_read_b64_tr_b16 v[34:35], v16 offset:3840
    ds_read_b64_tr_b16 v[36:37], v16 offset:3136
    ds_read_b64_tr_b16 v[38:39], v16 offset:3904
    s_waitcnt lgkmcnt(5)
    v_mfma_f32_32x32x16_bf16 v[44:59], a[16:19], v[20:23], v[44:59]
    v_mfma_f32_32x32x16_bf16 v[60:75], a[16:19], v[24:27], v[60:75]
    s_add_u32 m0, s73, 1024
    s_nop 0
    buffer_load_dwordx4 v3, s[4:7], s70 offen lds
    ds_read_b128 a[24:27], v12
    ds_read_b64_tr_b16 v[20:21], v16 offset:6144
    ds_read_b64_tr_b16 v[22:23], v16 offset:6912
    ds_read_b64_tr_b16 v[24:25], v16 offset:6208
    ds_read_b64_tr_b16 v[26:27], v16 offset:6976
    s_waitcnt lgkmcnt(5)
    v_mfma_f32_32x32x16_bf16 v[44:59], a[20:23], v[32:35], v[44:59]
    v_mfma_f32_32x32x16_bf16 v[60:75], a[20:23], v[36:39], v[60:75]
    s_add_u32 m0, s74, 0
    s_nop 0
    buffer_load_dwordx4 v4, s[8:11], s71 offen lds
    ds_read_b128 a[28:31], v13
    ds_read_b64_tr_b16 v[32:33], v16 offset:9216
    ds_read_b64_tr_b16 v[34:35], v16 offset:9984
    ds_read_b64_tr_b16 v[36:37], v16 offset:9280
    ds_read_b64_tr_b16 v[38:39], v16 offset:10048
    s_waitcnt lgkmcnt(5)
    v_mfma_f32_32x32x16_bf16 v[44:59], a[24:27], v[20:23], v[44:59]
    v_mfma_f32_32x32x16_bf16 v[60:75], a[24:27], v[24:27], v[60:75]
    s_waitcnt vmcnt(9) lgkmcnt(0)
    s_barrier
    s_cmp_lg_u32 s3, 0
    s_cbranch_scc1 L_rs_7
    s_cmp_ge_u32 s2, 2
    s_cbranch_scc1 L_rs_7
    v_mov_b32 v124, s2
    v_mov_b32 v125, 1
    s_mov_b64 exec, 1
    buffer_store_byte v125, v124, s[32:35], 0 offen sc1
    s_mov_b64 exec, -1
L_rs_7:
    v_add_u32 v10, 57344, v9
    v_xor_b32 v11, 32, v10
    v_xor_b32 v12, 64, v10
    v_xor_b32 v13, 96, v10
    v_add_u32 v16, 57344, v14
    ds_read_b128 a[32:35], v10
    ds_read_b64_tr_b16 v[20:21], v16 offset:0
    ds_read_b64_tr_b16 v[22:23], v16 offset:768
    ds_read_b64_tr_b16 v[24:25], v16 offset:64
    ds_read_b64_tr_b16 v[26:27], v16 offset:832
    v_mfma_f32_32x32x16_bf16 v[44:59], a[28:31], v[32:35], v[44:59]
    v_mfma_f32_32x32x16_bf16 v[60:75], a[28:31], v[36:39], v[60:75]
    s_add_u32 s93, s92, 6
    s_and_b32 s93, s93, 7
    s_lshl_b32 s70, s93, 7
    s_mul_i32 s71, s93, 196608
    s_add_u32 s70, s70, s94
    s_add_u32 s71, s71, s95
    s_add_u32 m0, s73, 28672
    s_nop 0
    buffer_load_dwordx4 v2, s[4:7], s70 offen lds
    ds_read_b128 a[36:39], v11
    ds_read_b64_tr_b16 v[32:33], v16 offset:3072
    ds_read_b64_tr_b16 v[34:35], v16 offset:3840
    ds_read_b64_tr_b16 v[36:37], v16 offset:3136
    ds_read_b64_tr_b16 v[38:39], v16 offset:3904
    s_waitcnt lgkmcnt(5)
    v_mfma_f32_32x32x16_bf16 v[44:59], a[32:35], v[20:23], v[44:59]
    v_mfma_f32_32x32x16_bf16 v[60:75], a[32:35], v[24:27], v[60:75]
    s_add_u32 m0, s73, 29696
    s_nop 0
    buffer_load_dwordx4 v3, s[4:7], s70 offen lds
    ds_read_b128 a[40:43], v12
    ds_read_b64_tr_b16 v[20:21], v16 offset:6144
    ds_read_b64_tr_b16 v[22:23], v16 offset:6912
    ds_read_b64_tr_b16 v[24:25], v16 offset:6208
    ds_read_b64_tr_b16 v[26:27], v16 offset:6976
    s_waitcnt lgkmcnt(5)
    v_mfma_f32_32x32x16_bf16 v[44:59], a[36:39], v[32:35], v[44:59]
    v_mfma_f32_32x32x16_bf16 v[60:75], a[36:39], v[36:39], v[60:75]
    s_add_u32 m0, s74, 28672
    s_nop 0
    buffer_load_dwordx4 v4, s[8:11], s71 offen lds
    ds_read_b128 a[44:47], v13
    ds_read_b64_tr_b16 v[32:33], v16 offset:9216
    ds_read_b64_tr_b16 v[34:35], v16 offset:9984
    ds_read_b64_tr_b16 v[36:37], v16 offset:9280
    ds_read_b64_tr_b16 v[38:39], v16 offset:10048
    s_waitcnt lgkmcnt(5)
    v_mfma_f32_32x32x16_bf16 v[44:59], a[40:43], v[20:23], v[44:59]
    v_mfma_f32_32x32x16_bf16 v[60:75], a[40:43], v[24:27], v[60:75]
    s_waitcnt vmcnt(9) lgkmcnt(0)
    s_barrier
    v_add_u32 v10, 86016, v9
    v_xor_b32 v11, 32, v10
    v_xor_b32 v12, 64, v10
    v_xor_b32 v13, 96, v10
    v_add_u32 v16, 86016, v14
    ds_read_b128 a[48:51], v10
    ds_read_b64_tr_b16 v[20:21], v16 offset:0
    ds_read_b64_tr_b16 v[22:23], v16 offset:768
    ds_read_b64_tr_b16 v[24:25], v16 offset:64
    ds_read_b64_tr_b16 v[26:27], v16 offset:832
    v_mfma_f32_32x32x16_bf16 v[44:59], a[44:47], v[32:35], v[44:59]
    v_mfma_f32_32x32x16_bf16 v[60:75], a[44:47], v[36:39], v[60:75]
    s_add_u32 s93, s92, 7
    s_and_b32 s93, s93, 7
    s_lshl_b32 s70, s93, 7
    s_mul_i32 s71, s93, 196608
    s_add_u32 s70, s70, s94
    s_add_u32 s71, s71, s95
    s_add_u32 m0, s73, 57344
    s_nop 0
    buffer_load_dwordx4 v2, s[4:7], s70 offen lds
    ds_read_b128 a[52:55], v11
    ds_read_b64_tr_b16 v[32:33], v16 offset:3072
    ds_read_b64_tr_b16 v[34:35], v16 offset:3840
    ds_read_b64_tr_b16 v[36:37], v16 offset:3136
    ds_read_b64_tr_b16 v[38:39], v16 offset:3904
    s_waitcnt lgkmcnt(5)
    v_mfma_f32_32x32x16_bf16 v[44:59], a[48:51], v[20:23], v[44:59]
    v_mfma_f32_32x32x16_bf16 v[60:75], a[48:51], v[24:27], v[60:75]
    s_add_u32 m0, s73, 58368
    s_nop 0
    buffer_load_dwordx4 v3, s[4:7], s70 offen lds
    ds_read_b128 a[56:59], v12
    ds_read_b64_tr_b16 v[20:21], v16 offset:6144
    ds_read_b64_tr_b16 v[22:23], v16 offset:6912
    ds_read_b64_tr_b16 v[24:25], v16 offset:6208
    ds_read_b64_tr_b16 v[26:27], v16 offset:6976
    s_waitcnt lgkmcnt(5)
    v_mfma_f32_32x32x16_bf16 v[44:59], a[52:55], v[32:35], v[44:59]
    v_mfma_f32_32x32x16_bf16 v[60:75], a[52:55], v[36:39], v[60:75]
    s_add_u32 m0, s74, 57344
    s_nop 0
    buffer_load_dwordx4 v4, s[8:11], s71 offen lds
    ds_read_b128 a[60:63], v13
    ds_read_b64_tr_b16 v[32:33], v16 offset:9216
    ds_read_b64_tr_b16 v[34:35], v16 offset:9984
    ds_read_b64_tr_b16 v[36:37], v16 offset:9280
    ds_read_b64_tr_b16 v[38:39], v16 offset:10048
    s_waitcnt lgkmcnt(5)
    v_mfma_f32_32x32x16_bf16 v[44:59], a[56:59], v[20:23], v[44:59]
    v_mfma_f32_32x32x16_bf16 v[60:75], a[56:59], v[24:27], v[60:75]
    s_waitcnt vmcnt(9) lgkmcnt(0)
    s_barrier
    v_add_u32 v10, 114688, v9
    v_xor_b32 v11, 32, v10
    v_xor_b32 v12, 64, v10
    v_xor_b32 v13, 96, v10
    v_add_u32 v16, 114688, v14
    ds_read_b128 a[64:67], v10
    ds_read_b64_tr_b16 v[20:21], v16 offset:0
    ds_read_b64_tr_b16 v[22:23], v16 offset:768
    ds_read_b64_tr_b16 v[24:25], v16 offset:64
    ds_read_b64_tr_b16 v[26:27], v16 offset:832
    v_mfma_f32_32x32x16_bf16 v[44:59], a[60:63], v[32:35], v[44:59]
    v_mfma_f32_32x32x16_bf16 v[60:75], a[60:63], v[36:39], v[60:75]
    s_add_u32 s93, s92, 0
    s_and_b32 s93, s93, 7
    s_mul_i32 s72, s93, 176128
    s_add_u32 s72, s72, s96
    s_add_u32 m0, s75, 86016
    s_nop 0
    buffer_load_dwordx4 v6, s[12:15], s72 offen lds
    ds_read_b128 a[68:71], v11
    ds_read_b64_tr_b16 v[32:33], v16 offset:3072
    ds_read_b64_tr_b16 v[34:35], v16 offset:3840
    ds_read_b64_tr_b16 v[36:37], v16 offset:3136
    ds_read_b64_tr_b16 v[38:39], v16 offset:3904
    s_waitcnt lgkmcnt(5)
    v_mfma_f32_32x32x16_bf16 v[44:59], a[64:67], v[20:23], v[44:59]
    v_mfma_f32_32x32x16_bf16 v[60:75], a[64:67], v[24:27], v[60:75]
    s_add_u32 m0, s75, 87040
    s_nop 0
    buffer_load_dwordx4 v7, s[12:15], s72 offen lds
    ds_read_b128 a[72:75], v12
    ds_read_b64_tr_b16 v[20:21], v16 offset:6144
    ds_read_b64_tr_b16 v[22:23], v16 offset:6912
    ds_read_b64_tr_b16 v[24:25], v16 offset:6208
    ds_read_b64_tr_b16 v[26:27], v16 offset:6976
    s_waitcnt lgkmcnt(5)
    v_mfma_f32_32x32x16_bf16 v[44:59], a[68:71], v[32:35], v[44:59]
    v_mfma_f32_32x32x16_bf16 v[60:75], a[68:71], v[36:39], v[60:75]
    s_add_u32 m0, s75, 88064
    s_nop 0
    buffer_load_dwordx4 v8, s[12:15], s72 offen lds
    ds_read_b128 a[76:79], v13
    ds_read_b64_tr_b16 v[32:33], v16 offset:9216
    ds_read_b64_tr_b16 v[34:35], v16 offset:9984
    ds_read_b64_tr_b16 v[36:37], v16 offset:9280
    ds_read_b64_tr_b16 v[38:39], v16 offset:10048
    s_waitcnt lgkmcnt(5)
    v_mfma_f32_32x32x16_bf16 v[44:59], a[72:75], v[20:23], v[44:59]
    v_mfma_f32_32x32x16_bf16 v[60:75], a[72:75], v[24:27], v[60:75]
    s_waitcnt vmcnt(9) lgkmcnt(0)
    s_barrier
    v_mov_b32 v125, 0x101
    s_cmp_eq_u32 s3, 0
    s_cselect_b64 exec, -1, 0
    buffer_load_dword v125, v126, s[32:35], 0 offen sc1
    s_mov_b64 exec, -1
    v_add_u32 v10, 0, v9
    v_xor_b32 v11, 32, v10
    v_xor_b32 v12, 64, v10
    v_xor_b32 v13, 96, v10
    v_add_u32 v16, 0, v14
    ds_read_b128 a[80:83], v10
    ds_read_b64_tr_b16 v[20:21], v16 offset:0
    ds_read_b64_tr_b16 v[22:23], v16 offset:768
    ds_read_b64_tr_b16 v[24:25], v16 offset:64
    ds_read_b64_tr_b16 v[26:27], v16 offset:832
    v_mfma_f32_32x32x16_bf16 v[44:59], a[76:79], v[32:35], v[44:59]
    v_mfma_f32_32x32x16_bf16 v[60:75], a[76:79], v[36:39], v[60:75]
    s_add_u32 s93, s92, 1
    s_and_b32 s93, s93, 7
    s_mul_i32 s72, s93, 176128
    s_add_u32 s72, s72, s96
    s_add_u32 m0, s75, 114688
    s_nop 0
    buffer_load_dwordx4 v6, s[12:15], s72 offen lds
    ds_read_b128 a[84:87], v11
    ds_read_b64_tr_b16 v[32:33], v16 offset:3072
    ds_read_b64_tr_b16 v[34:35], v16 offset:3840
    ds_read_b64_tr_b16 v[36:37], v16 offset:3136
    ds_read_b64_tr_b16 v[38:39], v16 offset:3904
    s_waitcnt lgkmcnt(5)
    v_mfma_f32_32x32x16_bf16 v[44:59], a[80:83], v[20:23], v[44:59]
    v_mfma_f32_32x32x16_bf16 v[60:75], a[80:83], v[24:27], v[60:75]
    s_add_u32 m0, s75, 115712
    s_nop 0
    buffer_load_dwordx4 v7, s[12:15], s72 offen lds
    ds_read_b128 a[88:91], v12
    ds_read_b64_tr_b16 v[20:21], v16 offset:6144
    ds_read_b64_tr_b16 v[22:23], v16 offset:6912
    ds_read_b64_tr_b16 v[24:25], v16 offset:6208
    ds_read_b64_tr_b16 v[26:27], v16 offset:6976
    s_waitcnt lgkmcnt(5)
    v_mfma_f32_32x32x16_bf16 v[44:59], a[84:87], v[32:35], v[44:59]
    v_mfma_f32_32x32x16_bf16 v[60:75], a[84:87], v[36:39], v[60:75]
    s_add_u32 m0, s75, 116736
    s_nop 0
    buffer_load_dwordx4 v8, s[12:15], s72 offen lds
    ds_read_b128 a[92:95], v13
    ds_read_b64_tr_b16 v[32:33], v16 offset:9216
    ds_read_b64_tr_b16 v[34:35], v16 offset:9984
    ds_read_b64_tr_b16 v[36:37], v16 offset:9280
    ds_read_b64_tr_b16 v[38:39], v16 offset:10048
    s_waitcnt lgkmcnt(5)
    v_mfma_f32_32x32x16_bf16 v[44:59], a[88:91], v[20:23], v[44:59]
    v_mfma_f32_32x32x16_bf16 v[60:75], a[88:91], v[24:27], v[60:75]
    s_waitcnt vmcnt(9) lgkmcnt(0)
    s_barrier
    v_add_u32 v10, 28672, v9
    v_xor_b32 v11, 32, v10
    v_xor_b32 v12, 64, v10
    v_xor_b32 v13, 96, v10
    v_add_u32 v16, 28672, v14
    ds_read_b128 a[96:99], v10
    ds_read_b64_tr_b16 v[20:21], v16 offset:0
    ds_read_b64_tr_b16 v[22:23], v16 offset:768
    ds_read_b64_tr_b16 v[24:25], v16 offset:64
    ds_read_b64_tr_b16 v[26:27], v16 offset:832
    v_mfma_f32_32x32x16_bf16 v[44:59], a[92:95], v[32:35], v[44:59]
    v_mfma_f32_32x32x16_bf16 v[60:75], a[92:95], v[36:39], v[60:75]
    s_add_u32 s93, s92, 2
    s_and_b32 s93, s93, 7
    s_mul_i32 s72, s93, 176128
    s_add_u32 s72, s72, s96
    s_add_u32 m0, s75, 0
    s_nop 0
    buffer_load_dwordx4 v6, s[12:15], s72 offen lds
    ds_read_b128 a[100:103], v11
    ds_read_b64_tr_b16 v[32:33], v16 offset:3072
    ds_read_b64_tr_b16 v[34:35], v16 offset:3840
    ds_read_b64_tr_b16 v[36:37], v16 offset:3136
    ds_read_b64_tr_b16 v[38:39], v16 offset:3904
    s_waitcnt lgkmcnt(5)
    v_mfma_f32_32x32x16_bf16 v[44:59], a[96:99], v[20:23], v[44:59]
    v_mfma_f32_32x32x16_bf16 v[60:75], a[96:99], v[24:27], v[60:75]
    s_add_u32 m0, s75, 1024
    s_nop 0
    buffer_load_dwordx4 v7, s[12:15], s72 offen lds
    ds_read_b128 a[104:107], v12
    ds_read_b64_tr_b16 v[20:21], v16 offset:6144
    ds_read_b64_tr_b16 v[22:23], v16 offset:6912
    ds_read_b64_tr_b16 v[24:25], v16 offset:6208
    ds_read_b64_tr_b16 v[26:27], v16 offset:6976
    s_waitcnt lgkmcnt(5)
    v_mfma_f32_32x32x16_bf16 v[44:59], a[100:103], v[32:35], v[44:59]
    v_mfma_f32_32x32x16_bf16 v[60:75], a[100:103], v[36:39], v[60:75]
    s_add_u32 m0, s75, 2048
    s_nop 0
    buffer_load_dwordx4 v8, s[12:15], s72 offen lds
    ds_read_b128 a[108:111], v13
    ds_read_b64_tr_b16 v[32:33], v16 offset:9216
    ds_read_b64_tr_b16 v[34:35], v16 offset:9984
    ds_read_b64_tr_b16 v[36:37], v16 offset:9280
    ds_read_b64_tr_b16 v[38:39], v16 offset:10048
    s_waitcnt lgkmcnt(5)
    v_mfma_f32_32x32x16_bf16 v[44:59], a[104:107], v[20:23], v[44:59]
    v_mfma_f32_32x32x16_bf16 v[60:75], a[104:107], v[24:27], v[60:75]
    s_waitcnt vmcnt(9) lgkmcnt(0)
    s_barrier
    v_add_u32 v10, 57344, v9
    v_xor_b32 v11, 32, v10
    v_xor_b32 v12, 64, v10
    v_xor_b32 v13, 96, v10
    v_add_u32 v16, 57344, v14
    ds_read_b128 a[112:115], v10
    ds_read_b64_tr_b16 v[20:21], v16 offset:0
    ds_read_b64_tr_b16 v[22:23], v16 offset:768
    ds_read_b64_tr_b16 v[24:25], v16 offset:64
    ds_read_b64_tr_b16 v[26:27], v16 offset:832
    v_mfma_f32_32x32x16_bf16 v[44:59], a[108:111], v[32:35], v[44:59]
    v_mfma_f32_32x32x16_bf16 v[60:75], a[108:111], v[36:39], v[60:75]
    s_add_u32 s93, s92, 3
    s_and_b32 s93, s93, 7
    s_mul_i32 s72, s93, 176128
    s_add_u32 s72, s72, s96
    s_add_u32 m0, s75, 28672
    s_nop 0
    buffer_load_dwordx4 v6, s[12:15], s72 offen lds
    ds_read_b128 a[116:119], v11
    ds_read_b64_tr_b16 v[32:33], v16 offset:3072
    ds_read_b64_tr_b16 v[34:35], v16 offset:3840
    ds_read_b64_tr_b16 v[36:37], v16 offset:3136
    ds_read_b64_tr_b16 v[38:39], v16 offset:3904
    s_waitcnt lgkmcnt(5)
    v_mfma_f32_32x32x16_bf16 v[44:59], a[112:115], v[20:23], v[44:59]
    v_mfma_f32_32x32x16_bf16 v[60:75], a[112:115], v[24:27], v[60:75]
    s_add_u32 m0, s75, 29696
    s_nop 0
    buffer_load_dwordx4 v7, s[12:15], s72 offen lds
    ds_read_b128 a[120:123], v12
    ds_read_b64_tr_b16 v[20:21], v16 offset:6144
    ds_read_b64_tr_b16 v[22:23], v16 offset:6912
    ds_read_b64_tr_b16 v[24:25], v16 offset:6208
    ds_read_b64_tr_b16 v[26:27], v16 offset:6976
    s_waitcnt lgkmcnt(5)
    v_mfma_f32_32x32x16_bf16 v[44:59], a[116:119], v[32:35], v[44:59]
    v_mfma_f32_32x32x16_bf16 v[60:75], a[116:119], v[36:39], v[60:75]
    s_add_u32 m0, s75, 30720
    s_nop 0
    buffer_load_dwordx4 v8, s[12:15], s72 offen lds
    ds_read_b128 a[124:127], v13
    ds_read_b64_tr_b16 v[32:33], v16 offset:9216
    ds_read_b64_tr_b16 v[34:35], v16 offset:9984
    ds_read_b64_tr_b16 v[36:37], v16 offset:9280
    ds_read_b64_tr_b16 v[38:39], v16 offset:10048
    s_waitcnt lgkmcnt(5)
    v_mfma_f32_32x32x16_bf16 v[44:59], a[120:123], v[20:23], v[44:59]
    v_mfma_f32_32x32x16_bf16 v[60:75], a[120:123], v[24:27], v[60:75]
    s_waitcnt vmcnt(9) lgkmcnt(0)
    s_cmp_lg_u32 s3, 0
    s_cbranch_scc1 L_pd_8
    s_mov_b32 s80, 400000
    s_waitcnt vmcnt(9)
L_pl_9:
    v_cmp_ne_u32 vcc, 0x101, v125
    s_nop 4
    s_cbranch_vccz L_pd_8
    s_sub_u32 s80, s80, 1
    s_cmp_eq_u32 s80, 0
    s_cbranch_scc1 L_pd_8
    buffer_load_dword v125, v126, s[32:35], 0 offen sc1
    s_waitcnt vmcnt(0)
    s_branch L_pl_9
L_pd_8:
    s_barrier
    v_add_u32 v16, 86016, v18
    ds_read_b64_tr_b16 v[20:21], v16 offset:0
    ds_read_b64_tr_b16 v[22:23], v16 offset:768
    ds_read_b64_tr_b16 v[24:25], v16 offset:32
    ds_read_b64_tr_b16 v[26:27], v16 offset:800
    ds_read_b64_tr_b16 v[28:29], v16 offset:64
    ds_read_b64_tr_b16 v[30:31], v16 offset:832
    v_mfma_f32_32x32x16_bf16 v[44:59], a[124:127], v[32:35], v[44:59]
    v_mfma_f32_32x32x16_bf16 v[60:75], a[124:127], v[36:39], v[60:75]
    s_add_u32 s93, s92, 4
    s_and_b32 s93, s93, 7
    s_mul_i32 s72, s93, 176128
    s_add_u32 s72, s72, s96
    s_add_u32 m0, s75, 57344
    s_nop 0
    buffer_load_dwordx4 v6, s[12:15], s72 offen lds
    ds_read_b64_tr_b16 v[32:33], v16 offset:3072
    ds_read_b64_tr_b16 v[34:35], v16 offset:3840
    ds_read_b64_tr_b16 v[36:37], v16 offset:3104
    ds_read_b64_tr_b16 v[38:39], v16 offset:3872
    ds_read_b64_tr_b16 v[40:41], v16 offset:3136
    ds_read_b64_tr_b16 v[42:43], v16 offset:3904
    s_waitcnt lgkmcnt(6)
    v_mfma_f32_32x32x16_bf16 v[76:91], v[20:23], a[0:3], 0
    v_mfma_f32_32x32x16_bf16 v[92:107], v[24:27], a[0:3], 0
    s_mul_i32 s97, s43, 3
    s_lshl_b32 s98, s42, 2
    s_and_b32 s99, s3, 3
    s_add_u32 s98, s98, s99
    s_lshl_b32 s98, s98, 10
    s_lshl_b32 s99, s97, 17
    s_add_u32 s99, s99, s98
    v_cndmask_b32 v10, v19, v1, vcc
    v_cvt_pk_bf16_f32 v44, v44, v45
    v_cvt_pk_bf16_f32 v45, v46, v47
    v_mfma_f32_32x32x16_bf16 v[108:123], v[28:31], a[0:3], 0
    v_cvt_pk_bf16_f32 v46, v48, v49
    v_cvt_pk_bf16_f32 v47, v50, v51
    buffer_store_dwordx4 v[44:47], v17, s[24:27], s99 offen offset:0 sc1
    v_cvt_pk_bf16_f32 v48, v52, v53
    v_cvt_pk_bf16_f32 v49, v54, v55
    s_add_u32 m0, s75, 58368
    s_nop 0
    buffer_load_dwordx4 v7, s[12:15], s72 offen lds
    ds_read_b64_tr_b16 v[20:21], v16 offset:6144
    ds_read_b64_tr_b16 v[22:23], v16 offset:6912
    ds_read_b64_tr_b16 v[24:25], v16 offset:6176
    ds_read_b64_tr_b16 v[26:27], v16 offset:6944
    ds_read_b64_tr_b16 v[28:29], v16 offset:6208
    ds_read_b64_tr_b16 v[30:31], v16 offset:6976
    s_waitcnt lgkmcnt(6)
    v_mfma_f32_32x32x16_bf16 v[76:91], v[32:35], a[4:7], v[76:91]
    v_cvt_pk_bf16_f32 v50, v56, v57
    v_cvt_pk_bf16_f32 v51, v58, v59
    buffer_store_dwordx4 v[48:51], v17, s[24:27], s99 offen offset:512 sc1
    s_add_u32 s97, s97, 1
    s_lshl_b32 s99, s97, 17
    s_add_u32 s99, s99, s98
    v_cndmask_b32 v10, v19, v1, vcc
    v_mfma_f32_32x32x16_bf16 v[92:107], v[36:39], a[4:7], v[92:107]
    v_cvt_pk_bf16_f32 v60, v60, v61
    v_cvt_pk_bf16_f32 v61, v62, v63
    v_cvt_pk_bf16_f32 v62, v64, v65
    v_cvt_pk_bf16_f32 v63, v66, v67
    buffer_store_dwordx4 v[60:63], v17, s[24:27], s99 offen offset:0 sc1
    v_mfma_f32_32x32x16_bf16 v[108:123], v[40:43], a[4:7], v[108:123]
    v_cvt_pk_bf16_f32 v64, v68, v69
    v_cvt_pk_bf16_f32 v65, v70, v71
    v_cvt_pk_bf16_f32 v66, v72, v73
    v_cvt_pk_bf16_f32 v67, v74, v75
    buffer_store_dwordx4 v[64:67], v17, s[24:27], s99 offen offset:512 sc1
    s_add_u32 m0, s75, 59392
    s_nop 0
    buffer_load_dwordx4 v8, s[12:15], s72 offen lds
    ds_read_b64_tr_b16 v[32:33], v16 offset:9216
    ds_read_b64_tr_b16 v[34:35], v16 offset:9984
    ds_read_b64_tr_b16 v[36:37], v16 offset:9248
    ds_read_b64_tr_b16 v[38:39], v16 offset:10016
    ds_read_b64_tr_b16 v[40:41], v16 offset:9280
    ds_read_b64_tr_b16 v[42:43], v16 offset:10048
    s_waitcnt lgkmcnt(6)
    v_mfma_f32_32x32x16_bf16 v[76:91], v[20:23], a[8:11], v[76:91]
    v_mfma_f32_32x32x16_bf16 v[92:107], v[24:27], a[8:11], v[92:107]
    v_mfma_f32_32x32x16_bf16 v[108:123], v[28:31], a[8:11], v[108:123]
    s_branch L_B1
L_ch1:
    s_cmp_ge_u32 s43, 10
    s_cbranch_scc1 L_A1V
    s_waitcnt vmcnt(5)
    s_barrier
    v_add_u32 v10, 0, v9
    v_xor_b32 v11, 32, v10
    v_xor_b32 v12, 64, v10
    v_xor_b32 v13, 96, v10
    v_add_u32 v16, 0, v14
    ds_read_b128 a[0:3], v10
    ds_read_b64_tr_b16 v[20:21], v16 offset:0
    ds_read_b64_tr_b16 v[22:23], v16 offset:768
    s_add_u32 s93, s92, 2
    s_and_b32 s93, s93, 7
    s_lshl_b32 s70, s93, 7
    s_mul_i32 s71, s93, 196608
    s_add_u32 s70, s70, s94
    s_add_u32 s71, s71, s95
    s_add_u32 m0, s73, 57344
    s_nop 0
    buffer_load_dwordx4 v2, s[4:7], s70 offen lds
    s_add_u32 m0, s73, 58368
    s_nop 0
    buffer_load_dwordx4 v3, s[4:7], s70 offen lds
    s_add_u32 m0, s74, 57344
    s_nop 0
    buffer_load_dwordx4 v4, s[8:11], s71 offen lds
    ds_read_b128 a[4:7], v11
    ds_read_b64_tr_b16 v[32:33], v16 offset:3072
    ds_read_b64_tr_b16 v[34:35], v16 offset:3840
    s_waitcnt lgkmcnt(3)
    v_mfma_f32_32x32x16_bf16 v[44:59], v[20:23], a[0:3], 0
    s_add_u32 m0, s74, 58368
    s_nop 0
    buffer_load_dwordx4 v5, s[8:11], s71 offen lds
    s_add_u32 s93, s92, 3
    s_and_b32 s93, s93, 7
    s_lshl_b32 s70, s93, 7
    s_mul_i32 s71, s93, 196608
    s_add_u32 s70, s70, s94
    s_add_u32 s71, s71, s95
    s_add_u32 m0, s73, 86016
    s_nop 0
    buffer_load_dwordx4 v2, s[4:7], s70 offen lds
    s_add_u32 m0, s73, 87040
    s_nop 0
    buffer_load_dwordx4 v3, s[4:7], s70 offen lds
    ds_read_b128 a[8:11], v12
    ds_read_b64_tr_b16 v[20:21], v16 offset:6144
    ds_read_b64_tr_b16 v[22:23], v16 offset:6912
    s_waitcnt lgkmcnt(3)
    v_mfma_f32_32x32x16_bf16 v[44:59], v[32:35], a[4:7], v[44:59]
    s_add_u32 m0, s74, 86016
    s_nop 0
    buffer_load_dwordx4 v4, s[8:11], s71 offen lds
    s_add_u32 m0, s74, 87040
    s_nop 0
    buffer_load_dwordx4 v5, s[8:11], s71 offen lds
    s_add_u32 s93, s92, 4
    s_and_b32 s93, s93, 7
    s_lshl_b32 s70, s93, 7
    s_mul_i32 s71, s93, 196608
    s_add_u32 s70, s70, s94
    s_add_u32 s71, s71, s95
    s_add_u32 m0, s73, 114688
    s_nop 0
    buffer_load_dwordx4 v2, s[4:7], s70 offen lds
    ds_read_b128 a[12:15], v13
    ds_read_b64_tr_b16 v[32:33], v16 offset:9216
    ds_read_b64_tr_b16 v[34:35], v16 offset:9984
    s_waitcnt lgkmcnt(3)
    v_mfma_f32_32x32x16_bf16 v[44:59], v[20:23], a[8:11], v[44:59]
    s_add_u32 m0, s73, 115712
    s_nop 0
    buffer_load_dwordx4 v3, s[4:7], s70 offen lds
    s_add_u32 m0, s74, 114688
    s_nop 0
    buffer_load_dwordx4 v4, s[8:11], s71 offen lds
    s_add_u32 m0, s74, 115712
    s_nop 0
    buffer_load_dwordx4 v5, s[8:11], s71 offen lds
    s_waitcnt vmcnt(13) lgkmcnt(0)
    s_barrier
    v_add_u32 v10, 28672, v9
    v_xor_b32 v11, 32, v10
    v_xor_b32 v12, 64, v10
    v_xor_b32 v13, 96, v10
    v_add_u32 v16, 28672, v14
    ds_read_b128 a[16:19], v10
    ds_read_b64_tr_b16 v[20:21], v16 offset:0
    ds_read_b64_tr_b16 v[22:23], v16 offset:768
    v_mfma_f32_32x32x16_bf16 v[44:59], v[32:35], a[12:15], v[44:59]
    s_add_u32 s93, s92, 5
    s_and_b32 s93, s93, 7
    s_lshl_b32 s70, s93, 7
    s_mul_i32 s71, s93, 196608
    s_add_u32 s70, s70, s94
    s_add_u32 s71, s71, s95
    s_add_u32 m0, s73, 0
    s_nop 0
    buffer_load_dwordx4 v2, s[4:7], s70 offen lds
    ds_read_b128 a[20:23], v11
    ds_read_b64_tr_b16 v[32:33], v16 offset:3072
    ds_read_b64_tr_b16 v[34:35], v16 offset:3840
    s_waitcnt lgkmcnt(3)
    v_mfma_f32_32x32x16_bf16 v[44:59], v[20:23], a[16:19], v[44:59]
    s_add_u32 m0, s73, 1024
    s_nop 0
    buffer_load_dwordx4 v3, s[4:7], s70 offen lds
    ds_read_b128 a[24:27], v12
    ds_read_b64_tr_b16 v[20:21], v16 offset:6144
    ds_read_b64_tr_b16 v[22:23], v16 offset:6912
    s_waitcnt lgkmcnt(3)
    v_mfma_f32_32x32x16_bf16 v[44:59], v[32:35], a[20:23], v[44:59]
    s_add_u32 m0, s74, 0
    s_nop 0
    buffer_load_dwordx4 v4, s[8:11], s71 offen lds
    ds_read_b128 a[28:31], v13
    ds_read_b64_tr_b16 v[32:33], v16 offset:9216
    ds_read_b64_tr_b16 v[34:35], v16 offset:9984
    s_waitcnt lgkmcnt(3)
    v_mfma_f32_32x32x16_bf16 v[44:59], v[20:23], a[24:27], v[44:59]
    s_add_u32 m0, s74, 1024
    s_nop 0
    buffer_load_dwordx4 v5, s[8:11], s71 offen lds
    s_waitcnt vmcnt(12) lgkmcnt(0)
    s_barrier
    s_cmp_lg_u32 s3, 0
    s_cbranch_scc1 L_rs_10
    s_cmp_ge_u32 s2, 2
    s_cbranch_scc1 L_rs_10
    v_mov_b32 v124, s2
    v_mov_b32 v125, 1
    s_mov_b64 exec, 1
    buffer_store_byte v125, v124, s[32:35], 0 offen sc1
    s_mov_b64 exec, -1
L_rs_10:
    v_add_u32 v10, 57344, v9
    v_xor_b32 v11, 32, v10
    v_xor_b32 v12, 64, v10
    v_xor_b32 v13, 96, v10
    v_add_u32 v16, 57344, v14
    ds_read_b128 a[32:35], v10
    ds_read_b64_tr_b16 v[20:21], v16 offset:0
    ds_read_b64_tr_b16 v[22:23], v16 offset:768
    v_mfma_f32_32x32x16_bf16 v[44:59], v[32:35], a[28:31], v[44:59]
    s_add_u32 s93, s92, 6
    s_and_b32 s93, s93, 7
    s_lshl_b32 s70, s93, 7
    s_mul_i32 s71, s93, 196608
    s_add_u32 s70, s70, s94
    s_add_u32 s71, s71, s95
    s_add_u32 m0, s73, 28672
    s_nop 0
    buffer_load_dwordx4 v2, s[4:7], s70 offen lds
    ds_read_b128 a[36:39], v11
    ds_read_b64_tr_b16 v[32:33], v16 offset:3072
    ds_read_b64_tr_b16 v[34:35], v16 offset:3840
    s_waitcnt lgkmcnt(3)
    v_mfma_f32_32x32x16_bf16 v[44:59], v[20:23], a[32:35], v[44:59]
    s_add_u32 m0, s73, 29696
    s_nop 0
    buffer_load_dwordx4 v3, s[4:7], s70 offen lds
    ds_read_b128 a[40:43], v12
    ds_read_b64_tr_b16 v[20:21], v16 offset:6144
    ds_read_b64_tr_b16 v[22:23], v16 offset:6912
    s_waitcnt lgkmcnt(3)
    v_mfma_f32_32x32x16_bf16 v[44:59], v[32:35], a[36:39], v[44:59]
    s_add_u32 m0, s74, 28672
    s_nop 0
    buffer_load_dwordx4 v4, s[8:11], s71 offen lds
    ds_read_b128 a[44:47], v13
    ds_read_b64_tr_b16 v[32:33], v16 offset:9216
    ds_read_b64_tr_b16 v[34:35], v16 offset:9984
    s_waitcnt lgkmcnt(3)
    v_mfma_f32_32x32x16_bf16 v[44:59], v[20:23], a[40:43], v[44:59]
    s_add_u32 m0, s74, 29696
    s_nop 0
    buffer_load_dwordx4 v5, s[8:11], s71 offen lds
    s_waitcnt vmcnt(12) lgkmcnt(0)
    s_barrier
    v_add_u32 v10, 86016, v9
    v_xor_b32 v11, 32, v10
    v_xor_b32 v12, 64, v10
    v_xor_b32 v13, 96, v10
    v_add_u32 v16, 86016, v14
    ds_read_b128 a[48:51], v10
    ds_read_b64_tr_b16 v[20:21], v16 offset:0
    ds_read_b64_tr_b16 v[22:23], v16 offset:768
    v_mfma_f32_32x32x16_bf16 v[44:59], v[32:35], a[44:47], v[44:59]
    s_add_u32 s93, s92, 7
    s_and_b32 s93, s93, 7
    s_lshl_b32 s70, s93, 7
    s_mul_i32 s71, s93, 196608
    s_add_u32 s70, s70, s94
    s_add_u32 s71, s71, s95
    s_add_u32 m0, s73, 57344
    s_nop 0
    buffer_load_dwordx4 v2, s[4:7], s70 offen lds
    ds_read_b128 a[52:55], v11
    ds_read_b64_tr_b16 v[32:33], v16 offset:3072
    ds_read_b64_tr_b16 v[34:35], v16 offset:3840
    s_waitcnt lgkmcnt(3)
    v_mfma_f32_32x32x16_bf16 v[44:59], v[20:23], a[48:51], v[44:59]
    s_add_u32 m0, s73, 58368
    s_nop 0
    buffer_load_dwordx4 v3, s[4:7], s70 offen lds
    ds_read_b128 a[56:59], v12
    ds_read_b64_tr_b16 v[20:21], v16 offset:6144
    ds_read_b64_tr_b16 v[22:23], v16 offset:6912
    s_waitcnt lgkmcnt(3)
    v_mfma_f32_32x32x16_bf16 v[44:59], v[32:35], a[52:55], v[44:59]
    s_add_u32 m0, s74, 57344
    s_nop 0
    buffer_load_dwordx4 v4, s[8:11], s71 offen lds
    ds_read_b128 a[60:63], v13
    ds_read_b64_tr_b16 v[32:33], v16 offset:9216
    ds_read_b64_tr_b16 v[34:35], v16 offset:9984
    s_waitcnt lgkmcnt(3)
    v_mfma_f32_32x32x16_bf16 v[44:59], v[20:23], a[56:59], v[44:59]
    s_add_u32 m0, s74, 58368
    s_nop 0
    buffer_load_dwordx4 v5, s[8:11], s71 offen lds
    s_waitcnt vmcnt(12) lgkmcnt(0)
    s_barrier
    v_add_u32 v10, 114688, v9
    v_xor_b32 v11, 32, v10
    v_xor_b32 v12, 64, v10
    v_xor_b32 v13, 96, v10
    v_add_u32 v16, 114688, v14
    ds_read_b128 a[64:67], v10
    ds_read_b64_tr_b16 v[20:21], v16 offset:0
    ds_read_b64_tr_b16 v[22:23], v16 offset:768
    v_mfma_f32_32x32x16_bf16 v[44:59], v[32:35], a[60:63], v[44:59]
    s_add_u32 s93, s92, 0
    s_and_b32 s93, s93, 7
    s_mul_i32 s72, s93, 176128
    s_add_u32 s72, s72, s96
    s_add_u32 m0, s75, 86016
    s_nop 0
    buffer_load_dwordx4 v6, s[12:15], s72 offen lds
    ds_read_b128 a[68:71], v11
    ds_read_b64_tr_b16 v[32:33], v16 offset:3072
    ds_read_b64_tr_b16 v[34:35], v16 offset:3840
    s_waitcnt lgkmcnt(3)
    v_mfma_f32_32x32x16_bf16 v[44:59], v[20:23], a[64:67], v[44:59]
    s_add_u32 m0, s75, 87040
    s_nop 0
    buffer_load_dwordx4 v7, s[12:15], s72 offen lds
    ds_read_b128 a[72:75], v12
    ds_read_b64_tr_b16 v[20:21], v16 offset:6144
    ds_read_b64_tr_b16 v[22:23], v16 offset:6912
    s_waitcnt lgkmcnt(3)
    v_mfma_f32_32x32x16_bf16 v[44:59], v[32:35], a[68:71], v[44:59]
    s_add_u32 m0, s75, 88064
    s_nop 0
    buffer_load_dwordx4 v8, s[12:15], s72 offen lds
    ds_read_b128 a[76:79], v13
    ds_read_b64_tr_b16 v[32:33], v16 offset:9216
    ds_read_b64_tr_b16 v[34:35], v16 offset:9984
    s_waitcnt lgkmcnt(3)
    v_mfma_f32_32x32x16_bf16 v[44:59], v[20:23], a[72:75], v[44:59]
    s_waitcnt vmcnt(11) lgkmcnt(0)
    s_barrier
    v_mov_b32 v125, 0x101
    s_cmp_eq_u32 s3, 0
    s_cselect_b64 exec, -1, 0
    buffer_load_dword v125, v126, s[32:35], 0 offen sc1
    s_mov_b64 exec, -1
    v_add_u32 v10, 0, v9
    v_xor_b32 v11, 32, v10
    v_xor_b32 v12, 64, v10
    v_xor_b32 v13, 96, v10
    v_add_u32 v16, 0, v14
    ds_read_b128 a[80:83], v10
    ds_read_b64_tr_b16 v[20:21], v16 offset:0
    ds_read_b64_tr_b16 v[22:23], v16 offset:768
    v_mfma_f32_32x32x16_bf16 v[44:59], v[32:35], a[76:79], v[44:59]
    s_add_u32 s93, s92, 1
    s_and_b32 s93, s93, 7
    s_mul_i32 s72, s93, 176128
    s_add_u32 s72, s72, s96
    s_add_u32 m0, s75, 114688
    s_nop 0
    buffer_load_dwordx4 v6, s[12:15], s72 offen lds
    ds_read_b128 a[84:87], v11
    ds_read_b64_tr_b16 v[32:33], v16 offset:3072
    ds_read_b64_tr_b16 v[34:35], v16 offset:3840
    s_waitcnt lgkmcnt(3)
    v_mfma_f32_32x32x16_bf16 v[44:59], v[20:23], a[80:83], v[44:59]
    s_add_u32 m0, s75, 115712
    s_nop 0
    buffer_load_dwordx4 v7, s[12:15], s72 offen lds
    ds_read_b128 a[88:91], v12
    ds_read_b64_tr_b16 v[20:21], v16 offset:6144
    ds_read_b64_tr_b16 v[22:23], v16 offset:6912
    s_waitcnt lgkmcnt(3)
    v_mfma_f32_32x32x16_bf16 v[44:59], v[32:35], a[84:87], v[44:59]
    s_add_u32 m0, s75, 116736
    s_nop 0
    buffer_load_dwordx4 v8, s[12:15], s72 offen lds
    ds_read_b128 a[92:95], v13
    ds_read_b64_tr_b16 v[32:33], v16 offset:9216
    ds_read_b64_tr_b16 v[34:35], v16 offset:9984
    s_waitcnt lgkmcnt(3)
    v_mfma_f32_32x32x16_bf16 v[44:59], v[20:23], a[88:91], v[44:59]
    s_waitcnt vmcnt(10) lgkmcnt(0)
    s_barrier
    v_add_u32 v10, 28672, v9
    v_xor_b32 v11, 32, v10
    v_xor_b32 v12, 64, v10
    v_xor_b32 v13, 96, v10
    v_add_u32 v16, 28672, v14
    ds_read_b128 a[96:99], v10
    ds_read_b64_tr_b16 v[20:21], v16 offset:0
    ds_read_b64_tr_b16 v[22:23], v16 offset:768
    v_mfma_f32_32x32x16_bf16 v[44:59], v[32:35], a[92:95], v[44:59]
    s_add_u32 s93, s92, 2
    s_and_b32 s93, s93, 7
    s_mul_i32 s72, s93, 176128
    s_add_u32 s72, s72, s96
    s_add_u32 m0, s75, 0
    s_nop 0
    buffer_load_dwordx4 v6, s[12:15], s72 offen lds
    ds_read_b128 a[100:103], v11
    ds_read_b64_tr_b16 v[32:33], v16 offset:3072
    ds_read_b64_tr_b16 v[34:35], v16 offset:3840
    s_waitcnt lgkmcnt(3)
    v_mfma_f32_32x32x16_bf16 v[44:59], v[20:23], a[96:99], v[44:59]
    s_add_u32 m0, s75, 1024
    s_nop 0
    buffer_load_dwordx4 v7, s[12:15], s72 offen lds
    ds_read_b128 a[104:107], v12
    ds_read_b64_tr_b16 v[20:21], v16 offset:6144
    ds_read_b64_tr_b16 v[22:23], v16 offset:6912
    s_waitcnt lgkmcnt(3)
    v_mfma_f32_32x32x16_bf16 v[44:59], v[32:35], a[100:103], v[44:59]
    s_add_u32 m0, s75, 2048
    s_nop 0
    buffer_load_dwordx4 v8, s[12:15], s72 offen lds
    ds_read_b128 a[108:111], v13
    ds_read_b64_tr_b16 v[32:33], v16 offset:9216
    ds_read_b64_tr_b16 v[34:35], v16 offset:9984
    s_waitcnt lgkmcnt(3)
    v_mfma_f32_32x32x16_bf16 v[44:59], v[20:23], a[104:107], v[44:59]
    s_waitcnt vmcnt(9) lgkmcnt(0)
    s_barrier
    v_add_u32 v10, 57344, v9
    v_xor_b32 v11, 32, v10
    v_xor_b32 v12, 64, v10
    v_xor_b32 v13, 96, v10
    v_add_u32 v16, 57344, v14
    ds_read_b128 a[112:115], v10
    ds_read_b64_tr_b16 v[20:21], v16 offset:0
    ds_read_b64_tr_b16 v[22:23], v16 offset:768
    v_mfma_f32_32x32x16_bf16 v[44:59], v[32:35], a[108:111], v[44:59]
    s_add_u32 s93, s92, 3
    s_and_b32 s93, s93, 7
    s_mul_i32 s72, s93, 176128
    s_add_u32 s72, s72, s96
    s_add_u32 m0, s75, 28672
    s_nop 0
    buffer_load_dwordx4 v6, s[12:15], s72 offen lds
    ds_read_b128 a[116:119], v11
    ds_read_b64_tr_b16 v[32:33], v16 offset:3072
    ds_read_b64_tr_b16 v[34:35], v16 offset:3840
    s_waitcnt lgkmcnt(3)
    v_mfma_f32_32x32x16_bf16 v[44:59], v[20:23], a[112:115], v[44:59]
    s_add_u32 m0, s75, 29696
    s_nop 0
    buffer_load_dwordx4 v7, s[12:15], s72 offen lds
    ds_read_b128 a[120:123], v12
    ds_read_b64_tr_b16 v[20:21], v16 offset:6144
    ds_read_b64_tr_b16 v[22:23], v16 offset:6912
    s_waitcnt lgkmcnt(3)
    v_mfma_f32_32x32x16_bf16 v[44:59], v[32:35], a[116:119], v[44:59]
    s_add_u32 m0, s75, 30720
    s_nop 0
    buffer_load_dwordx4 v8, s[12:15], s72 offen lds
    ds_read_b128 a[124:127], v13
    ds_read_b64_tr_b16 v[32:33], v16 offset:9216
    ds_read_b64_tr_b16 v[34:35], v16 offset:9984
    s_waitcnt lgkmcnt(3)
    v_mfma_f32_32x32x16_bf16 v[44:59], v[20:23], a[120:123], v[44:59]
    s_waitcnt vmcnt(9) lgkmcnt(0)
    s_cmp_lg_u32 s3, 0
    s_cbranch_scc1 L_pd_11
    s_mov_b32 s80, 400000
    s_waitcnt vmcnt(9)
L_pl_12:
    v_cmp_ne_u32 vcc, 0x101, v125
    s_nop 4
    s_cbranch_vccz L_pd_11
    s_sub_u32 s80, s80, 1
    s_cmp_eq_u32 s80, 0
    s_cbranch_scc1 L_pd_11
    buffer_load_dword v125, v126, s[32:35], 0 offen sc1
    s_waitcnt vmcnt(0)
    s_branch L_pl_12
L_pd_11:
    s_barrier
    v_add_u32 v16, 86016, v18
    ds_read_b64_tr_b16 v[20:21], v16 offset:0
    ds_read_b64_tr_b16 v[22:23], v16 offset:768
    ds_read_b64_tr_b16 v[24:25], v16 offset:32
    ds_read_b64_tr_b16 v[26:27], v16 offset:800
    ds_read_b64_tr_b16 v[28:29], v16 offset:64
    ds_read_b64_tr_b16 v[30:31], v16 offset:832
    v_mfma_f32_32x32x16_bf16 v[44:59], v[32:35], a[124:127], v[44:59]
    s_add_u32 s93, s92, 4
    s_and_b32 s93, s93, 7
    s_mul_i32 s72, s93, 176128
    s_add_u32 s72, s72, s96
    s_add_u32 m0, s75, 57344
    s_nop 0
    buffer_load_dwordx4 v6, s[12:15], s72 offen lds
    ds_read_b64_tr_b16 v[32:33], v16 offset:3072
    ds_read_b64_tr_b16 v[34:35], v16 offset:3840
    ds_read_b64_tr_b16 v[36:37], v16 offset:3104
    ds_read_b64_tr_b16 v[38:39], v16 offset:3872
    ds_read_b64_tr_b16 v[40:41], v16 offset:3136
    ds_read_b64_tr_b16 v[42:43], v16 offset:3904
    s_waitcnt lgkmcnt(6)
    v_mfma_f32_32x32x16_bf16 v[76:91], v[20:23], a[0:3], 0
    v_mfma_f32_32x32x16_bf16 v[92:107], v[24:27], a[0:3], 0
    s_mul_i32 s97, s43, 3
    s_add_u32 s97, s97, 2
    s_lshl_b32 s98, s42, 2
    s_and_b32 s99, s3, 3
    s_add_u32 s98, s98, s99
    s_lshl_b32 s98, s98, 10
    s_lshl_b32 s99, s97, 17
    s_add_u32 s99, s99, s98
    s_cmp_lt_u32 s97, 16
    s_cselect_b32 s100, 0x3eb8aa3b, 1.0
    s_cselect_b64 vcc, -1, 0
    v_cndmask_b32 v10, v19, v1, vcc
    v_mul_f32 v44, s100, v44
    v_mul_f32 v45, s100, v45
    v_mul_f32 v46, s100, v46
    v_mfma_f32_32x32x16_bf16 v[108:123], v[28:31], a[0:3], 0
    v_mul_f32 v47, s100, v47
    v_mul_f32 v48, s100, v48
    v_mul_f32 v49, s100, v49
    v_mul_f32 v50, s100, v50
    v_mul_f32 v51, s100, v51
    v_cvt_pk_bf16_f32 v44, v44, v45
    s_add_u32 m0, s75, 58368
    s_nop 0
    buffer_load_dwordx4 v7, s[12:15], s72 offen lds
    ds_read_b64_tr_b16 v[20:21], v16 offset:6144
    ds_read_b64_tr_b16 v[22:23], v16 offset:6912
    ds_read_b64_tr_b16 v[24:25], v16 offset:6176
    ds_read_b64_tr_b16 v[26:27], v16 offset:6944
    ds_read_b64_tr_b16 v[28:29], v16 offset:6208
    ds_read_b64_tr_b16 v[30:31], v16 offset:6976
    s_waitcnt lgkmcnt(6)
    v_mfma_f32_32x32x16_bf16 v[76:91], v[32:35], a[4:7], v[76:91]
    v_cvt_pk_bf16_f32 v45, v46, v47
    v_cvt_pk_bf16_f32 v46, v48, v49
    v_cvt_pk_bf16_f32 v47, v50, v51
    buffer_store_dwordx4 v[44:47], v10, s[24:27], s99 offen sc1
    v_mul_f32 v52, s100, v52
    v_mul_f32 v53, s100, v53
    v_mfma_f32_32x32x16_bf16 v[92:107], v[36:39], a[4:7], v[92:107]
    v_mul_f32 v54, s100, v54
    v_mul_f32 v55, s100, v55
    v_mul_f32 v56, s100, v56
    v_mul_f32 v57, s100, v57
    v_mul_f32 v58, s100, v58
    v_mul_f32 v59, s100, v59
    v_mfma_f32_32x32x16_bf16 v[108:123], v[40:43], a[4:7], v[108:123]
    v_cvt_pk_bf16_f32 v48, v52, v53
    v_cvt_pk_bf16_f32 v49, v54, v55
    v_cvt_pk_bf16_f32 v50, v56, v57
    v_cvt_pk_bf16_f32 v51, v58, v59
    s_add_u32 s99, s99, 65536
    buffer_store_dwordx4 v[48:51], v10, s[24:27], s99 offen sc1
    s_add_u32 m0, s75, 59392
    s_nop 0
    buffer_load_dwordx4 v8, s[12:15], s72 offen lds
    ds_read_b64_tr_b16 v[32:33], v16 offset:9216
    ds_read_b64_tr_b16 v[34:35], v16 offset:9984
    ds_read_b64_tr_b16 v[36:37], v16 offset:9248
    ds_read_b64_tr_b16 v[38:39], v16 offset:10016
    ds_read_b64_tr_b16 v[40:41], v16 offset:9280
    ds_read_b64_tr_b16 v[42:43], v16 offset:10048
    s_waitcnt lgkmcnt(6)
    v_mfma_f32_32x32x16_bf16 v[76:91], v[20:23], a[8:11], v[76:91]
    v_mfma_f32_32x32x16_bf16 v[92:107], v[24:27], a[8:11], v[92:107]
    v_mfma_f32_32x32x16_bf16 v[108:123], v[28:31], a[8:11], v[108:123]
    s_branch L_B1
L_A1V:
    s_waitcnt vmcnt(5)
    s_barrier
    v_add_u32 v10, 0, v9
    v_xor_b32 v11, 32, v10
    v_xor_b32 v12, 64, v10
    v_xor_b32 v13, 96, v10
    v_add_u32 v16, 0, v14
    ds_read_b128 a[0:3], v10
    ds_read_b64_tr_b16 v[20:21], v16 offset:0
    ds_read_b64_tr_b16 v[22:23], v16 offset:768
    s_add_u32 s93, s92, 2
    s_and_b32 s93, s93, 7
    s_lshl_b32 s70, s93, 7
    s_mul_i32 s71, s93, 196608
    s_add_u32 s70, s70, s94
    s_add_u32 s71, s71, s95
    s_add_u32 m0, s73, 57344
    s_nop 0
    buffer_load_dwordx4 v2, s[4:7], s70 offen lds
    s_add_u32 m0, s73, 58368
    s_nop 0
    buffer_load_dwordx4 v3, s[4:7], s70 offen lds
    s_add_u32 m0, s74, 57344
    s_nop 0
    buffer_load_dwordx4 v4, s[8:11], s71 offen lds
    ds_read_b128 a[4:7], v11
    ds_read_b64_tr_b16 v[32:33], v16 offset:3072
    ds_read_b64_tr_b16 v[34:35], v16 offset:3840
    s_waitcnt lgkmcnt(3)
    v_mfma_f32_32x32x16_bf16 v[44:59], a[0:3], v[20:23], 0
    s_add_u32 m0, s74, 58368
    s_nop 0
    buffer_load_dwordx4 v5, s[8:11], s71 offen lds
    s_add_u32 s93, s92, 3
    s_and_b32 s93, s93, 7
    s_lshl_b32 s70, s93, 7
    s_mul_i32 s71, s93, 196608
    s_add_u32 s70, s70, s94
    s_add_u32 s71, s71, s95
    s_add_u32 m0, s73, 86016
    s_nop 0
    buffer_load_dwordx4 v2, s[4:7], s70 offen lds
    s_add_u32 m0, s73, 87040
    s_nop 0
    buffer_load_dwordx4 v3, s[4:7], s70 offen lds
    ds_read_b128 a[8:11], v12
    ds_read_b64_tr_b16 v[20:21], v16 offset:6144
    ds_read_b64_tr_b16 v[22:23], v16 offset:6912
    s_waitcnt lgkmcnt(3)
    v_mfma_f32_32x32x16_bf16 v[44:59], a[4:7], v[32:35], v[44:59]
    s_add_u32 m0, s74, 86016
    s_nop 0
    buffer_load_dwordx4 v4, s[8:11], s71 offen lds
    s_add_u32 m0, s74, 87040
    s_nop 0
    buffer_load_dwordx4 v5, s[8:11], s71 offen lds
    s_add_u32 s93, s92, 4
    s_and_b32 s93, s93, 7
    s_lshl_b32 s70, s93, 7
    s_mul_i32 s71, s93, 196608
    s_add_u32 s70, s70, s94
    s_add_u32 s71, s71, s95
    s_add_u32 m0, s73, 114688
    s_nop 0
    buffer_load_dwordx4 v2, s[4:7], s70 offen lds
    ds_read_b128 a[12:15], v13
    ds_read_b64_tr_b16 v[32:33], v16 offset:9216
    ds_read_b64_tr_b16 v[34:35], v16 offset:9984
    s_waitcnt lgkmcnt(3)
    v_mfma_f32_32x32x16_bf16 v[44:59], a[8:11], v[20:23], v[44:59]
    s_add_u32 m0, s73, 115712
    s_nop 0
    buffer_load_dwordx4 v3, s[4:7], s70 offen lds
    s_add_u32 m0, s74, 114688
    s_nop 0
    buffer_load_dwordx4 v4, s[8:11], s71 offen lds
    s_add_u32 m0, s74, 115712
    s_nop 0
    buffer_load_dwordx4 v5, s[8:11], s71 offen lds
    s_waitcnt vmcnt(13) lgkmcnt(0)
    s_barrier
    v_add_u32 v10, 28672, v9
    v_xor_b32 v11, 32, v10
    v_xor_b32 v12, 64, v10
    v_xor_b32 v13, 96, v10
    v_add_u32 v16, 28672, v14
    ds_read_b128 a[16:19], v10
    ds_read_b64_tr_b16 v[20:21], v16 offset:0
    ds_read_b64_tr_b16 v[22:23], v16 offset:768
    v_mfma_f32_32x32x16_bf16 v[44:59], a[12:15], v[32:35], v[44:59]
    s_add_u32 s93, s92, 5
    s_and_b32 s93, s93, 7
    s_lshl_b32 s70, s93, 7
    s_mul_i32 s71, s93, 196608
    s_add_u32 s70, s70, s94
    s_add_u32 s71, s71, s95
    s_add_u32 m0, s73, 0
    s_nop 0
    buffer_load_dwordx4 v2, s[4:7], s70 offen lds
    ds_read_b128 a[20:23], v11
    ds_read_b64_tr_b16 v[32:33], v16 offset:3072
    ds_read_b64_tr_b16 v[34:35], v16 offset:3840
    s_waitcnt lgkmcnt(3)
    v_mfma_f32_32x32x16_bf16 v[44:59], a[16:19], v[20:23], v[44:59]
    s_add_u32 m0, s73, 1024
    s_nop 0
    buffer_load_dwordx4 v3, s[4:7], s70 offen lds
    ds_read_b128 a[24:27], v12
    ds_read_b64_tr_b16 v[20:21], v16 offset:6144
    ds_read_b64_tr_b16 v[22:23], v16 offset:6912
    s_waitcnt lgkmcnt(3)
    v_mfma_f32_32x32x16_bf16 v[44:59], a[20:23], v[32:35], v[44:59]
    s_add_u32 m0, s74, 0
    s_nop 0
    buffer_load_dwordx4 v4, s[8:11], s71 offen lds
    ds_read_b128 a[28:31], v13
    ds_read_b64_tr_b16 v[32:33], v16 offset:9216
    ds_read_b64_tr_b16 v[34:35], v16 offset:9984
    s_waitcnt lgkmcnt(3)
    v_mfma_f32_32x32x16_bf16 v[44:59], a[24:27], v[20:23], v[44:59]
    s_add_u32 m0, s74, 1024
    s_nop 0
    buffer_load_dwordx4 v5, s[8:11], s71 offen lds
    s_waitcnt vmcnt(12) lgkmcnt(0)
    s_barrier
    s_cmp_lg_u32 s3, 0
    s_cbranch_scc1 L_rs_13
    s_cmp_ge_u32 s2, 2
    s_cbranch_scc1 L_rs_13
    v_mov_b32 v124, s2
    v_mov_b32 v125, 1
    s_mov_b64 exec, 1
    buffer_store_byte v125, v124, s[32:35], 0 offen sc1
    s_mov_b64 exec, -1
L_rs_13:
    v_add_u32 v10, 57344, v9
    v_xor_b32 v11, 32, v10
    v_xor_b32 v12, 64, v10
    v_xor_b32 v13, 96, v10
    v_add_u32 v16, 57344, v14
    ds_read_b128 a[32:35], v10
    ds_read_b64_tr_b16 v[20:21], v16 offset:0
    ds_read_b64_tr_b16 v[22:23], v16 offset:768
    v_mfma_f32_32x32x16_bf16 v[44:59], a[28:31], v[32:35], v[44:59]
    s_add_u32 s93, s92, 6
    s_and_b32 s93, s93, 7
    s_lshl_b32 s70, s93, 7
    s_mul_i32 s71, s93, 196608
    s_add_u32 s70, s70, s94
    s_add_u32 s71, s71, s95
    s_add_u32 m0, s73, 28672
    s_nop 0
    buffer_load_dwordx4 v2, s[4:7], s70 offen lds
    ds_read_b128 a[36:39], v11
    ds_read_b64_tr_b16 v[32:33], v16 offset:3072
    ds_read_b64_tr_b16 v[34:35], v16 offset:3840
    s_waitcnt lgkmcnt(3)
    v_mfma_f32_32x32x16_bf16 v[44:59], a[32:35], v[20:23], v[44:59]
    s_add_u32 m0, s73, 29696
    s_nop 0
    buffer_load_dwordx4 v3, s[4:7], s70 offen lds
    ds_read_b128 a[40:43], v12
    ds_read_b64_tr_b16 v[20:21], v16 offset:6144
    ds_read_b64_tr_b16 v[22:23], v16 offset:6912
    s_waitcnt lgkmcnt(3)
    v_mfma_f32_32x32x16_bf16 v[44:59], a[36:39], v[32:35], v[44:59]
    s_add_u32 m0, s74, 28672
    s_nop 0
    buffer_load_dwordx4 v4, s[8:11], s71 offen lds
    ds_read_b128 a[44:47], v13
    ds_read_b64_tr_b16 v[32:33], v16 offset:9216
    ds_read_b64_tr_b16 v[34:35], v16 offset:9984
    s_waitcnt lgkmcnt(3)
    v_mfma_f32_32x32x16_bf16 v[44:59], a[40:43], v[20:23], v[44:59]
    s_add_u32 m0, s74, 29696
    s_nop 0
    buffer_load_dwordx4 v5, s[8:11], s71 offen lds
    s_waitcnt vmcnt(12) lgkmcnt(0)
    s_barrier
    v_add_u32 v10, 86016, v9
    v_xor_b32 v11, 32, v10
    v_xor_b32 v12, 64, v10
    v_xor_b32 v13, 96, v10
    v_add_u32 v16, 86016, v14
    ds_read_b128 a[48:51], v10
    ds_read_b64_tr_b16 v[20:21], v16 offset:0
    ds_read_b64_tr_b16 v[22:23], v16 offset:768
    v_mfma_f32_32x32x16_bf16 v[44:59], a[44:47], v[32:35], v[44:59]
    s_add_u32 s93, s92, 7
    s_and_b32 s93, s93, 7
    s_lshl_b32 s70, s93, 7
    s_mul_i32 s71, s93, 196608
    s_add_u32 s70, s70, s94
    s_add_u32 s71, s71, s95
    s_add_u32 m0, s73, 57344
    s_nop 0
    buffer_load_dwordx4 v2, s[4:7], s70 offen lds
    ds_read_b128 a[52:55], v11
    ds_read_b64_tr_b16 v[32:33], v16 offset:3072
    ds_read_b64_tr_b16 v[34:35], v16 offset:3840
    s_waitcnt lgkmcnt(3)
    v_mfma_f32_32x32x16_bf16 v[44:59], a[48:51], v[20:23], v[44:59]
    s_add_u32 m0, s73, 58368
    s_nop 0
    buffer_load_dwordx4 v3, s[4:7], s70 offen lds
    ds_read_b128 a[56:59], v12
    ds_read_b64_tr_b16 v[20:21], v16 offset:6144
    ds_read_b64_tr_b16 v[22:23], v16 offset:6912
    s_waitcnt lgkmcnt(3)
    v_mfma_f32_32x32x16_bf16 v[44:59], a[52:55], v[32:35], v[44:59]
    s_add_u32 m0, s74, 57344
    s_nop 0
    buffer_load_dwordx4 v4, s[8:11], s71 offen lds
    ds_read_b128 a[60:63], v13
    ds_read_b64_tr_b16 v[32:33], v16 offset:9216
    ds_read_b64_tr_b16 v[34:35], v16 offset:9984
    s_waitcnt lgkmcnt(3)
    v_mfma_f32_32x32x16_bf16 v[44:59], a[56:59], v[20:23], v[44:59]
    s_add_u32 m0, s74, 58368
    s_nop 0
    buffer_load_dwordx4 v5, s[8:11], s71 offen lds
    s_waitcnt vmcnt(12) lgkmcnt(0)
    s_barrier
    v_add_u32 v10, 114688, v9
    v_xor_b32 v11, 32, v10
    v_xor_b32 v12, 64, v10
    v_xor_b32 v13, 96, v10
    v_add_u32 v16, 114688, v14
    ds_read_b128 a[64:67], v10
    ds_read_b64_tr_b16 v[20:21], v16 offset:0
    ds_read_b64_tr_b16 v[22:23], v16 offset:768
    v_mfma_f32_32x32x16_bf16 v[44:59], a[60:63], v[32:35], v[44:59]
    s_add_u32 s93, s92, 0
    s_and_b32 s93, s93, 7
    s_mul_i32 s72, s93, 176128
    s_add_u32 s72, s72, s96
    s_add_u32 m0, s75, 86016
    s_nop 0
    buffer_load_dwordx4 v6, s[12:15], s72 offen lds
    ds_read_b128 a[68:71], v11
    ds_read_b64_tr_b16 v[32:33], v16 offset:3072
    ds_read_b64_tr_b16 v[34:35], v16 offset:3840
    s_waitcnt lgkmcnt(3)
    v_mfma_f32_32x32x16_bf16 v[44:59], a[64:67], v[20:23], v[44:59]
    s_add_u32 m0, s75, 87040
    s_nop 0
    buffer_load_dwordx4 v7, s[12:15], s72 offen lds
    ds_read_b128 a[72:75], v12
    ds_read_b64_tr_b16 v[20:21], v16 offset:6144
    ds_read_b64_tr_b16 v[22:23], v16 offset:6912
    s_waitcnt lgkmcnt(3)
    v_mfma_f32_32x32x16_bf16 v[44:59], a[68:71], v[32:35], v[44:59]
    s_add_u32 m0, s75, 88064
    s_nop 0
    buffer_load_dwordx4 v8, s[12:15], s72 offen lds
    ds_read_b128 a[76:79], v13
    ds_read_b64_tr_b16 v[32:33], v16 offset:9216
    ds_read_b64_tr_b16 v[34:35], v16 offset:9984
    s_waitcnt lgkmcnt(3)
    v_mfma_f32_32x32x16_bf16 v[44:59], a[72:75], v[20:23], v[44:59]
    s_waitcnt vmcnt(11) lgkmcnt(0)
    s_barrier
    v_mov_b32 v125, 0x101
    s_cmp_eq_u32 s3, 0
    s_cselect_b64 exec, -1, 0
    buffer_load_dword v125, v126, s[32:35], 0 offen sc1
    s_mov_b64 exec, -1
    v_add_u32 v10, 0, v9
    v_xor_b32 v11, 32, v10
    v_xor_b32 v12, 64, v10
    v_xor_b32 v13, 96, v10
    v_add_u32 v16, 0, v14
    ds_read_b128 a[80:83], v10
    ds_read_b64_tr_b16 v[20:21], v16 offset:0
    ds_read_b64_tr_b16 v[22:23], v16 offset:768
    v_mfma_f32_32x32x16_bf16 v[44:59], a[76:79], v[32:35], v[44:59]
    s_add_u32 s93, s92, 1
    s_and_b32 s93, s93, 7
    s_mul_i32 s72, s93, 176128
    s_add_u32 s72, s72, s96
    s_add_u32 m0, s75, 114688
    s_nop 0
    buffer_load_dwordx4 v6, s[12:15], s72 offen lds
    ds_read_b128 a[84:87], v11
    ds_read_b64_tr_b16 v[32:33], v16 offset:3072
    ds_read_b64_tr_b16 v[34:35], v16 offset:3840
    s_waitcnt lgkmcnt(3)
    v_mfma_f32_32x32x16_bf16 v[44:59], a[80:83], v[20:23], v[44:59]
    s_add_u32 m0, s75, 115712
    s_nop 0
    buffer_load_dwordx4 v7, s[12:15], s72 offen lds
    ds_read_b128 a[88:91], v12
    ds_read_b64_tr_b16 v[20:21], v16 offset:6144
    ds_read_b64_tr_b16 v[22:23], v16 offset:6912
    s_waitcnt lgkmcnt(3)
    v_mfma_f32_32x32x16_bf16 v[44:59], a[84:87], v[32:35], v[44:59]
    s_add_u32 m0, s75, 116736
    s_nop 0
    buffer_load_dwordx4 v8, s[12:15], s72 offen lds
    ds_read_b128 a[92:95], v13
    ds_read_b64_tr_b16 v[32:33], v16 offset:9216
    ds_read_b64_tr_b16 v[34:35], v16 offset:9984
    s_waitcnt lgkmcnt(3)
    v_mfma_f32_32x32x16_bf16 v[44:59], a[88:91], v[20:23], v[44:59]
    s_waitcnt vmcnt(10) lgkmcnt(0)
    s_barrier
    v_add_u32 v10, 28672, v9
    v_xor_b32 v11, 32, v10
    v_xor_b32 v12, 64, v10
    v_xor_b32 v13, 96, v10
    v_add_u32 v16, 28672, v14
    ds_read_b128 a[96:99], v10
    ds_read_b64_tr_b16 v[20:21], v16 offset:0
    ds_read_b64_tr_b16 v[22:23], v16 offset:768
    v_mfma_f32_32x32x16_bf16 v[44:59], a[92:95], v[32:35], v[44:59]
    s_add_u32 s93, s92, 2
    s_and_b32 s93, s93, 7
    s_mul_i32 s72, s93, 176128
    s_add_u32 s72, s72, s96
    s_add_u32 m0, s75, 0
    s_nop 0
    buffer_load_dwordx4 v6, s[12:15], s72 offen lds
    ds_read_b128 a[100:103], v11
    ds_read_b64_tr_b16 v[32:33], v16 offset:3072
    ds_read_b64_tr_b16 v[34:35], v16 offset:3840
    s_waitcnt lgkmcnt(3)
    v_mfma_f32_32x32x16_bf16 v[44:59], a[96:99], v[20:23], v[44:59]
    s_add_u32 m0, s75, 1024
    s_nop 0
    buffer_load_dwordx4 v7, s[12:15], s72 offen lds
    ds_read_b128 a[104:107], v12
    ds_read_b64_tr_b16 v[20:21], v16 offset:6144
    ds_read_b64_tr_b16 v[22:23], v16 offset:6912
    s_waitcnt lgkmcnt(3)
    v_mfma_f32_32x32x16_bf16 v[44:59], a[100:103], v[32:35], v[44:59]
    s_add_u32 m0, s75, 2048
    s_nop 0
    buffer_load_dwordx4 v8, s[12:15], s72 offen lds
    ds_read_b128 a[108:111], v13
    ds_read_b64_tr_b16 v[32:33], v16 offset:9216
    ds_read_b64_tr_b16 v[34:35], v16 offset:9984
    s_waitcnt lgkmcnt(3)
    v_mfma_f32_32x32x16_bf16 v[44:59], a[104:107], v[20:23], v[44:59]
    s_waitcnt vmcnt(9) lgkmcnt(0)
    s_barrier
    v_add_u32 v10, 57344, v9
    v_xor_b32 v11, 32, v10
    v_xor_b32 v12, 64, v10
    v_xor_b32 v13, 96, v10
    v_add_u32 v16, 57344, v14
    ds_read_b128 a[112:115], v10
    ds_read_b64_tr_b16 v[20:21], v16 offset:0
    ds_read_b64_tr_b16 v[22:23], v16 offset:768
    v_mfma_f32_32x32x16_bf16 v[44:59], a[108:111], v[32:35], v[44:59]
    s_add_u32 s93, s92, 3
    s_and_b32 s93, s93, 7
    s_mul_i32 s72, s93, 176128
    s_add_u32 s72, s72, s96
    s_add_u32 m0, s75, 28672
    s_nop 0
    buffer_load_dwordx4 v6, s[12:15], s72 offen lds
    ds_read_b128 a[116:119], v11
    ds_read_b64_tr_b16 v[32:33], v16 offset:3072
    ds_read_b64_tr_b16 v[34:35], v16 offset:3840
    s_waitcnt lgkmcnt(3)
    v_mfma_f32_32x32x16_bf16 v[44:59], a[112:115], v[20:23], v[44:59]
    s_add_u32 m0, s75, 29696
    s_nop 0
    buffer_load_dwordx4 v7, s[12:15], s72 offen lds
    ds_read_b128 a[120:123], v12
    ds_read_b64_tr_b16 v[20:21], v16 offset:6144
    ds_read_b64_tr_b16 v[22:23], v16 offset:6912
    s_waitcnt lgkmcnt(3)
    v_mfma_f32_32x32x16_bf16 v[44:59], a[116:119], v[32:35], v[44:59]
    s_add_u32 m0, s75, 30720
    s_nop 0
    buffer_load_dwordx4 v8, s[12:15], s72 offen lds
    ds_read_b128 a[124:127], v13
    ds_read_b64_tr_b16 v[32:33], v16 offset:9216
    ds_read_b64_tr_b16 v[34:35], v16 offset:9984
    s_waitcnt lgkmcnt(3)
    v_mfma_f32_32x32x16_bf16 v[44:59], a[120:123], v[20:23], v[44:59]
    s_waitcnt vmcnt(9) lgkmcnt(0)
    s_cmp_lg_u32 s3, 0
    s_cbranch_scc1 L_pd_14
    s_mov_b32 s80, 400000
    s_waitcnt vmcnt(9)
L_pl_15:
    v_cmp_ne_u32 vcc, 0x101, v125
    s_nop 4
    s_cbranch_vccz L_pd_14
    s_sub_u32 s80, s80, 1
    s_cmp_eq_u32 s80, 0
    s_cbranch_scc1 L_pd_14
    buffer_load_dword v125, v126, s[32:35], 0 offen sc1
    s_waitcnt vmcnt(0)
    s_branch L_pl_15
L_pd_14:
    s_barrier
    v_add_u32 v16, 86016, v18
    ds_read_b64_tr_b16 v[20:21], v16 offset:0
    ds_read_b64_tr_b16 v[22:23], v16 offset:768
    ds_read_b64_tr_b16 v[24:25], v16 offset:32
    ds_read_b64_tr_b16 v[26:27], v16 offset:800
    ds_read_b64_tr_b16 v[28:29], v16 offset:64
    ds_read_b64_tr_b16 v[30:31], v16 offset:832
    v_mfma_f32_32x32x16_bf16 v[44:59], a[124:127], v[32:35], v[44:59]
    s_add_u32 s93, s92, 4
    s_and_b32 s93, s93, 7
    s_mul_i32 s72, s93, 176128
    s_add_u32 s72, s72, s96
    s_add_u32 m0, s75, 57344
    s_nop 0
    buffer_load_dwordx4 v6, s[12:15], s72 offen lds
    ds_read_b64_tr_b16 v[32:33], v16 offset:3072
    ds_read_b64_tr_b16 v[34:35], v16 offset:3840
    ds_read_b64_tr_b16 v[36:37], v16 offset:3104
    ds_read_b64_tr_b16 v[38:39], v16 offset:3872
    ds_read_b64_tr_b16 v[40:41], v16 offset:3136
    ds_read_b64_tr_b16 v[42:43], v16 offset:3904
    s_waitcnt lgkmcnt(6)
    v_mfma_f32_32x32x16_bf16 v[76:91], v[20:23], a[0:3], 0
    v_mfma_f32_32x32x16_bf16 v[92:107], v[24:27], a[0:3], 0
    s_mul_i32 s97, s43, 3
    s_add_u32 s97, s97, 2
    s_lshl_b32 s98, s42, 2
    s_and_b32 s99, s3, 3
    s_add_u32 s98, s98, s99
    s_lshl_b32 s98, s98, 10
    s_lshl_b32 s99, s97, 17
    s_add_u32 s99, s99, s98
    v_cndmask_b32 v10, v19, v1, vcc
    v_mfma_f32_32x32x16_bf16 v[108:123], v[28:31], a[0:3], 0
    v_cvt_pk_bf16_f32 v44, v44, v45
    v_cvt_pk_bf16_f32 v45, v46, v47
    v_cvt_pk_bf16_f32 v46, v48, v49
    s_add_u32 m0, s75, 58368
    s_nop 0
    buffer_load_dwordx4 v7, s[12:15], s72 offen lds
    ds_read_b64_tr_b16 v[20:21], v16 offset:6144
    ds_read_b64_tr_b16 v[22:23], v16 offset:6912
    ds_read_b64_tr_b16 v[24:25], v16 offset:6176
    ds_read_b64_tr_b16 v[26:27], v16 offset:6944
    ds_read_b64_tr_b16 v[28:29], v16 offset:6208
    ds_read_b64_tr_b16 v[30:31], v16 offset:6976
    s_waitcnt lgkmcnt(6)
    v_mfma_f32_32x32x16_bf16 v[76:91], v[32:35], a[4:7], v[76:91]
    v_cvt_pk_bf16_f32 v47, v50, v51
    buffer_store_dwordx4 v[44:47], v17, s[24:27], s99 offen offset:0 sc1
    v_cvt_pk_bf16_f32 v48, v52, v53
    v_mfma_f32_32x32x16_bf16 v[92:107], v[36:39], a[4:7], v[92:107]
    v_cvt_pk_bf16_f32 v49, v54, v55
    v_cvt_pk_bf16_f32 v50, v56, v57
    v_mfma_f32_32x32x16_bf16 v[108:123], v[40:43], a[4:7], v[108:123]
    v_cvt_pk_bf16_f32 v51, v58, v59
    buffer_store_dwordx4 v[48:51], v17, s[24:27], s99 offen offset:512 sc1
    s_add_u32 m0, s75, 59392
    s_nop 0
    buffer_load_dwordx4 v8, s[12:15], s72 offen lds
    ds_read_b64_tr_b16 v[32:33], v16 offset:9216
    ds_read_b64_tr_b16 v[34:35], v16 offset:9984
    ds_read_b64_tr_b16 v[36:37], v16 offset:9248
    ds_read_b64_tr_b16 v[38:39], v16 offset:10016
    ds_read_b64_tr_b16 v[40:41], v16 offset:9280
    ds_read_b64_tr_b16 v[42:43], v16 offset:10048
    s_waitcnt lgkmcnt(6)
    v_mfma_f32_32x32x16_bf16 v[76:91], v[20:23], a[8:11], v[76:91]
    v_mfma_f32_32x32x16_bf16 v[92:107], v[24:27], a[8:11], v[92:107]
    v_mfma_f32_32x32x16_bf16 v[108:123], v[28:31], a[8:11], v[108:123]
L_B1:
    s_cmp_eq_u32 s43, 15
    s_cbranch_scc1 L_G
    s_waitcnt lgkmcnt(0)
    v_mfma_f32_32x32x16_bf16 v[76:91], v[32:35], a[12:15], v[76:91]
    s_waitcnt vmcnt(11)
    s_barrier
    v_add_u32 v16, 57344, v18
    v_add_u32 v17, 114688, v18
    ds_read_b64_tr_b16 v[20:21], v17 offset:0
    ds_read_b64_tr_b16 v[22:23], v17 offset:768
    ds_read_b64_tr_b16 v[24:25], v17 offset:32
    ds_read_b64_tr_b16 v[26:27], v17 offset:800
    s_add_u32 s93, s92, 5
    s_and_b32 s93, s93, 7
    s_mul_i32 s72, s93, 176128
    s_add_u32 s72, s72, s96
    s_add_u32 m0, s75, 86016
    s_nop 0
    buffer_load_dwordx4 v6, s[12:15], s72 offen lds
    v_mfma_f32_32x32x16_bf16 v[92:107], v[36:39], a[12:15], v[92:107]
    ds_read_b64_tr_b16 v[28:29], v17 offset:64
    ds_read_b64_tr_b16 v[30:31], v17 offset:832
    ds_read_b64_tr_b16 v[52:53], v17 offset:3072
    ds_read_b64_tr_b16 v[54:55], v17 offset:3840
    s_add_u32 m0, s75, 87040
    s_nop 0
    buffer_load_dwordx4 v7, s[12:15], s72 offen lds
    v_mfma_f32_32x32x16_bf16 v[108:123], v[40:43], a[12:15], v[108:123]
    ds_read_b64_tr_b16 v[56:57], v17 offset:3104
    ds_read_b64_tr_b16 v[58:59], v17 offset:3872
    ds_read_b64_tr_b16 v[68:69], v17 offset:3136
    ds_read_b64_tr_b16 v[70:71], v17 offset:3904
    s_add_u32 m0, s75, 88064
    s_nop 0
    buffer_load_dwordx4 v8, s[12:15], s72 offen lds
    s_waitcnt lgkmcnt(10)
    v_mfma_f32_32x32x16_bf16 v[76:91], v[20:23], a[16:19], v[76:91]
    ds_read_b64_tr_b16 v[72:73], v17 offset:6144
    ds_read_b64_tr_b16 v[74:75], v17 offset:6912
    ds_read_b64_tr_b16 v[32:33], v17 offset:6176
    ds_read_b64_tr_b16 v[34:35], v17 offset:6944
    s_waitcnt lgkmcnt(12)
    v_mfma_f32_32x32x16_bf16 v[92:107], v[24:27], a[16:19], v[92:107]
    ds_read_b64_tr_b16 v[36:37], v17 offset:6208
    ds_read_b64_tr_b16 v[38:39], v17 offset:6976
    ds_read_b64_tr_b16 v[20:21], v17 offset:9216
    ds_read_b64_tr_b16 v[22:23], v17 offset:9984
    s_waitcnt lgkmcnt(14)
    v_mfma_f32_32x32x16_bf16 v[108:123], v[28:31], a[16:19], v[108:123]
    ds_read_b64_tr_b16 v[24:25], v17 offset:9248
    ds_read_b64_tr_b16 v[26:27], v17 offset:10016
    ds_read_b64_tr_b16 v[28:29], v17 offset:9280
    ds_read_b64_tr_b16 v[30:31], v17 offset:10048
    s_waitcnt lgkmcnt(15)
    v_mfma_f32_32x32x16_bf16 v[76:91], v[52:55], a[20:23], v[76:91]
    s_waitcnt lgkmcnt(14)
    v_mfma_f32_32x32x16_bf16 v[92:107], v[56:59], a[20:23], v[92:107]
    s_waitcnt vmcnt(4) lgkmcnt(0)
    s_barrier
    ds_read_b64_tr_b16 v[52:53], v18 offset:0
    ds_read_b64_tr_b16 v[54:55], v18 offset:768
    ds_read_b64_tr_b16 v[56:57], v18 offset:32
    ds_read_b64_tr_b16 v[58:59], v18 offset:800
    v_mov_b32 v124, 0
    v_mov_b32 v125, 1
    s_cmp_eq_u32 s3, 0
    s_cselect_b64 exec, 1, 0
    buffer_store_dword v125, v124, s[24:27], s85 offen sc1
    s_mov_b64 exec, -1
    v_mfma_f32_32x32x16_bf16 v[108:123], v[68:71], a[20:23], v[108:123]
    ds_read_b64_tr_b16 v[68:69], v18 offset:64
    ds_read_b64_tr_b16 v[70:71], v18 offset:832
    s_add_u32 s93, s92, 6
    s_and_b32 s93, s93, 7
    s_mul_i32 s72, s93, 176128
    s_add_u32 s72, s72, s96
    s_add_u32 m0, s75, 114688
    s_nop 0
    buffer_load_dwordx4 v6, s[12:15], s72 offen lds
    v_mfma_f32_32x32x16_bf16 v[76:91], v[72:75], a[24:27], v[76:91]
    ds_read_b64_tr_b16 v[72:73], v18 offset:3072
    ds_read_b64_tr_b16 v[74:75], v18 offset:3840
    s_add_u32 m0, s75, 115712
    s_nop 0
    buffer_load_dwordx4 v7, s[12:15], s72 offen lds
    v_mfma_f32_32x32x16_bf16 v[92:107], v[32:35], a[24:27], v[92:107]
    ds_read_b64_tr_b16 v[32:33], v18 offset:3104
    ds_read_b64_tr_b16 v[34:35], v18 offset:3872
    s_add_u32 m0, s75, 116736
    s_nop 0
    buffer_load_dwordx4 v8, s[12:15], s72 offen lds
    v_mfma_f32_32x32x16_bf16 v[108:123], v[36:39], a[24:27], v[108:123]
    ds_read_b64_tr_b16 v[36:37], v18 offset:3136
    ds_read_b64_tr_b16 v[38:39], v18 offset:3904
    v_mfma_f32_32x32x16_bf16 v[76:91], v[20:23], a[28:31], v[76:91]
    ds_read_b64_tr_b16 v[20:21], v18 offset:6144
    ds_read_b64_tr_b16 v[22:23], v18 offset:6912
    v_mfma_f32_32x32x16_bf16 v[92:107], v[24:27], a[28:31], v[92:107]
    ds_read_b64_tr_b16 v[24:25], v18 offset:6176
    ds_read_b64_tr_b16 v[26:27], v18 offset:6944
    v_mfma_f32_32x32x16_bf16 v[108:123], v[28:31], a[28:31], v[108:123]
    ds_read_b64_tr_b16 v[28:29], v18 offset:6208
    ds_read_b64_tr_b16 v[30:31], v18 offset:6976
    s_waitcnt lgkmcnt(15)
    v_mfma_f32_32x32x16_bf16 v[76:91], v[52:55], a[32:35], v[76:91]
    ds_read_b64_tr_b16 v[52:53], v18 offset:9216
    ds_read_b64_tr_b16 v[54:55], v18 offset:9984
    s_waitcnt lgkmcnt(15)
    v_mfma_f32_32x32x16_bf16 v[92:107], v[56:59], a[32:35], v[92:107]
    ds_read_b64_tr_b16 v[56:57], v18 offset:9248
    ds_read_b64_tr_b16 v[58:59], v18 offset:10016
    s_waitcnt lgkmcnt(15)
    v_mfma_f32_32x32x16_bf16 v[108:123], v[68:71], a[32:35], v[108:123]
    ds_read_b64_tr_b16 v[68:69], v18 offset:9280
    ds_read_b64_tr_b16 v[70:71], v18 offset:10048
    s_waitcnt lgkmcnt(15)
    v_mfma_f32_32x32x16_bf16 v[76:91], v[72:75], a[36:39], v[76:91]
    s_waitcnt lgkmcnt(14)
    v_mfma_f32_32x32x16_bf16 v[92:107], v[32:35], a[36:39], v[92:107]
    s_waitcnt lgkmcnt(0)
    s_barrier
    ds_read_b64_tr_b16 v[72:73], v18 offset:28672
    ds_read_b64_tr_b16 v[74:75], v18 offset:29440
    ds_read_b64_tr_b16 v[32:33], v18 offset:28704
    ds_read_b64_tr_b16 v[34:35], v18 offset:29472
    s_add_u32 s93, s92, 7
    s_and_b32 s93, s93, 7
    s_mul_i32 s72, s93, 176128
    s_add_u32 s72, s72, s96
    s_add_u32 m0, s75, 0
    s_nop 0
    buffer_load_dwordx4 v6, s[12:15], s72 offen lds
    s_add_u32 m0, s75, 1024
    s_nop 0
    buffer_load_dwordx4 v7, s[12:15], s72 offen lds
    s_add_u32 m0, s75, 2048
    s_nop 0
    buffer_load_dwordx4 v8, s[12:15], s72 offen lds
    s_lshr_b32 s76, s44, 1
    s_add_u32 s77, s76, 16
    s_mul_i32 s77, s77, 171
    s_lshr_b32 s77, s77, 9
    v_mfma_f32_32x32x16_bf16 v[108:123], v[36:39], a[36:39], v[108:123]
    ds_read_b64_tr_b16 v[36:37], v18 offset:28736
    ds_read_b64_tr_b16 v[38:39], v18 offset:29504
    s_add_u32 s78, s76, 32
    s_mul_i32 s78, s78, 171
    s_lshr_b32 s78, s78, 9
    s_add_u32 s79, s76, 0
    s_mul_i32 s79, s79, 171
    s_lshr_b32 s79, s79, 9
    s_lshl_b32 s76, s45, 1
    v_mfma_f32_32x32x16_bf16 v[76:91], v[20:23], a[40:43], v[76:91]
    ds_read_b64_tr_b16 v[20:21], v18 offset:31744
    ds_read_b64_tr_b16 v[22:23], v18 offset:32512
    v_mov_b32 v124, s78
    v_mov_b32 v125, s77
    v_cmp_gt_u32 vcc, 16, v0
    v_cndmask_b32 v124, v124, v125, vcc
    v_mov_b32 v125, s79
    v_cmp_gt_u32 vcc, 32, v0
    v_cndmask_b32 v124, v125, v124, vcc
    v_mfma_f32_32x32x16_bf16 v[92:107], v[24:27], a[40:43], v[92:107]
    ds_read_b64_tr_b16 v[24:25], v18 offset:31776
    ds_read_b64_tr_b16 v[26:27], v18 offset:32544
    v_and_b32 v125, 1, v0
    v_add_u32 v125, s76, v125
    v_and_b32 v126, 15, v0
    v_cndmask_b32 v126, v125, v126, vcc
    v_lshlrev_b32 v124, 9, v124
    v_lshrrev_b32 v125, 2, v126
    v_lshl_add_u32 v124, v125, 7, v124
    v_mfma_f32_32x32x16_bf16 v[108:123], v[28:31], a[40:43], v[108:123]
    ds_read_b64_tr_b16 v[28:29], v18 offset:31808
    ds_read_b64_tr_b16 v[30:31], v18 offset:32576
    v_and_b32 v126, 3, v126
    v_lshl_add_u32 v126, v126, 2, v124
    v_add_u32 v126, 0xe80000, v126
    s_lshr_b32 s76, s46, 1
    s_add_u32 s76, s76, 16
    s_lshl_b32 s77, s45, 1
    v_mfma_f32_32x32x16_bf16 v[76:91], v[52:55], a[44:47], v[76:91]
    ds_read_b64_tr_b16 v[52:53], v18 offset:34816
    ds_read_b64_tr_b16 v[54:55], v18 offset:35584
    s_add_u32 s77, s77, 16
    s_lshr_b32 s78, s46, 2
    v_and_b32 v124, 1, v0
    v_add_u32 v124, s77, v124
    v_mov_b32 v125, s76
    v_cmp_gt_u32 vcc, 16, v0
    v_mfma_f32_32x32x16_bf16 v[92:107], v[56:59], a[44:47], v[92:107]
    ds_read_b64_tr_b16 v[56:57], v18 offset:34848
    ds_read_b64_tr_b16 v[58:59], v18 offset:35616
    v_cndmask_b32 v124, v124, v125, vcc
    v_and_b32 v10, 15, v0
    v_cndmask_b32 v125, 15, v10, vcc
    v_cmp_gt_u32 vcc, 32, v0
    s_and_b32 s79, s78, 1
    s_lshl_b32 s79, s79, 2
    v_mfma_f32_32x32x16_bf16 v[108:123], v[68:71], a[44:47], v[108:123]
    ds_read_b64_tr_b16 v[68:69], v18 offset:34880
    ds_read_b64_tr_b16 v[70:71], v18 offset:35648
    v_and_b32 v10, 3, v0
    v_add_u32 v10, s79, v10
    v_cndmask_b32 v10, v10, v125, vcc
    v_bfe_u32 v125, v0, 2, 1
    v_lshlrev_b32 v125, 3, v125
    v_cndmask_b32 v125, v125, 0, vcc
    s_waitcnt lgkmcnt(15)
    v_mfma_f32_32x32x16_bf16 v[76:91], v[72:75], a[48:51], v[76:91]
    ds_read_b64_tr_b16 v[72:73], v18 offset:37888
    ds_read_b64_tr_b16 v[74:75], v18 offset:38656
    v_add_u32 v10, v10, v125
    s_lshr_b32 s78, s78, 1
    v_bfe_u32 v125, v0, 3, 2
    v_lshlrev_b32 v125, 2, v125
    v_add_u32 v125, s78, v125
    v_cndmask_b32 v124, v125, v124, vcc
    s_waitcnt lgkmcnt(15)
    v_mfma_f32_32x32x16_bf16 v[92:107], v[32:35], a[48:51], v[92:107]
    ds_read_b64_tr_b16 v[32:33], v18 offset:37920
    ds_read_b64_tr_b16 v[34:35], v18 offset:38688
    v_lshlrev_b32 v124, 9, v124
    v_lshrrev_b32 v125, 2, v10
    v_lshl_add_u32 v124, v125, 7, v124
    v_and_b32 v10, 3, v10
    v_lshl_add_u32 v10, v10, 2, v124
    v_add_u32 v10, 0xe80000, v10
    s_waitcnt lgkmcnt(15)
    v_mfma_f32_32x32x16_bf16 v[108:123], v[36:39], a[48:51], v[108:123]
    ds_read_b64_tr_b16 v[36:37], v18 offset:37952
    ds_read_b64_tr_b16 v[38:39], v18 offset:38720
    s_waitcnt lgkmcnt(15)
    v_mfma_f32_32x32x16_bf16 v[76:91], v[20:23], a[52:55], v[76:91]
    s_waitcnt lgkmcnt(14)
    v_mfma_f32_32x32x16_bf16 v[92:107], v[24:27], a[52:55], v[92:107]
    s_waitcnt vmcnt(9) lgkmcnt(0)
    s_barrier
    ds_read_b64_tr_b16 v[20:21], v16 offset:0
    ds_read_b64_tr_b16 v[22:23], v16 offset:768
    ds_read_b64_tr_b16 v[24:25], v16 offset:32
    ds_read_b64_tr_b16 v[26:27], v16 offset:800
    v_mov_b32 v125, 1
    s_cmp_eq_u32 s3, 0
    s_cselect_b64 exec, -1, 0
    buffer_load_dword v125, v126, s[24:27], 0 offen sc1
    s_mov_b64 exec, -1
    v_mov_b32 v44, 0xc0135761
    v_mov_b32 v45, 0xc0135761
    v_mov_b32 v46, 0xbdd2d3e8
    v_mov_b32 v47, 0xbdd2d3e8
    v_mov_b32 v48, 0x3f800000
    v_mov_b32 v49, 0x3f800000
    s_lshl_b32 s97, s42, 2
    s_and_b32 s98, s3, 3
    s_add_u32 s97, s97, s98
    s_mul_i32 s97, s97, 88
    s_mul_i32 s99, s43, 6
    s_min_u32 s98, s99, 80
    s_lshr_b32 s100, s3, 2
    s_mul_i32 s100, s100, 3
    s_add_u32 s98, s98, s100
    s_add_u32 s97, s97, s98
    s_lshl_b32 s97, s97, 10
    s_add_u32 s97, s97, 8388608
    v_lshrrev_b32 v9, 5, v0
    v_mfma_f32_32x32x16_bf16 v[108:123], v[28:31], a[52:55], v[108:123]
    ds_read_b64_tr_b16 v[28:29], v16 offset:64
    ds_read_b64_tr_b16 v[30:31], v16 offset:832
    v_and_b32 v3, 15, v0
    v_lshlrev_b32 v3, 4, v3
    v_lshl_add_u32 v3, v9, 8, v3
    v_mfma_f32_32x32x16_bf16 v[76:91], v[52:55], a[56:59], v[76:91]
    ds_read_b64_tr_b16 v[52:53], v16 offset:3072
    ds_read_b64_tr_b16 v[54:55], v16 offset:3840
    v_add_u32 v43, 98304, v3
    v_add_u32 v3, 32768, v3
    v_add_u32 v41, 28672, v1
    v_mfma_f32_32x32x16_bf16 v[92:107], v[56:59], a[56:59], v[92:107]
    ds_read_b64_tr_b16 v[56:57], v16 offset:3104
    ds_read_b64_tr_b16 v[58:59], v16 offset:3872
    v_add_u32 v42, 94208, v1
    v_bfe_u32 v4, v0, 4, 1
    v_lshlrev_b32 v5, 2, v4
    v_mfma_f32_32x32x16_bf16 v[108:123], v[68:71], a[56:59], v[108:123]
    ds_read_b64_tr_b16 v[68:69], v16 offset:3136
    ds_read_b64_tr_b16 v[70:71], v16 offset:3904
    v_xor_b32 v5, v5, v0
    v_and_b32 v5, 7, v5
    v_lshrrev_b32 v6, 3, v0
    v_mfma_f32_32x32x16_bf16 v[76:91], v[72:75], a[60:63], v[76:91]
    ds_read_b64_tr_b16 v[72:73], v16 offset:6144
    ds_read_b64_tr_b16 v[74:75], v16 offset:6912
    v_lshlrev_b32 v6, 10, v6
    v_lshl_add_u32 v8, v5, 4, v6
    v_bfe_u32 v5, v0, 2, 2
    v_mfma_f32_32x32x16_bf16 v[92:107], v[32:35], a[60:63], v[92:107]
    ds_read_b64_tr_b16 v[32:33], v16 offset:6176
    ds_read_b64_tr_b16 v[34:35], v16 offset:6944
    v_lshl_add_u32 v6, v9, 2, v5
    v_lshlrev_b32 v6, 7, v6
    v_lshl_add_u32 v6, v4, 5, v6
    v_mfma_f32_32x32x16_bf16 v[108:123], v[36:39], a[60:63], v[108:123]
    ds_read_b64_tr_b16 v[36:37], v16 offset:6208
    ds_read_b64_tr_b16 v[38:39], v16 offset:6976
    v_and_b32 v7, 3, v0
    v_lshl_add_u32 v6, v7, 3, v6
    s_waitcnt lgkmcnt(15)
    v_mfma_f32_32x32x16_bf16 v[76:91], v[20:23], a[64:67], v[76:91]
    ds_read_b64_tr_b16 v[20:21], v16 offset:9216
    ds_read_b64_tr_b16 v[22:23], v16 offset:9984
    v_lshrrev_b32 v5, 1, v5
    v_lshl_add_u32 v6, v5, 6, v6
    s_waitcnt lgkmcnt(15)
    v_mfma_f32_32x32x16_bf16 v[92:107], v[24:27], a[64:67], v[92:107]
    ds_read_b64_tr_b16 v[24:25], v16 offset:9248
    ds_read_b64_tr_b16 v[26:27], v16 offset:10016
    s_lshr_b32 s76, s3, 1
    s_lshl_b32 s77, s76, 12
    v_add_u32 v4, s77, v6
    v_xor_b32 v5, 64, v4
    s_lshl_b32 s77, s3, 14
    s_lshl_b32 s78, s47, 7
    s_add_u32 s72, s77, s78
    s_lshl_b32 s73, s3, 11
    s_and_b32 s77, s3, 1
    s_lshl_b32 s78, s46, 1
    s_add_u32 s77, s77, s78
    s_lshl_b32 s76, s76, 1
    s_mul_i32 s78, s77, 88
    s_add_u32 s78, s78, s76
    s_lshl_b32 s78, s78, 10
    s_add_u32 s74, s78, 8388608
    s_lshl_b32 s78, s77, 5
    s_add_u32 s78, s78, s76
    s_lshl_b32 s78, s78, 10
    s_add_u32 s75, s78, 6291456
    v_and_b32 v9, 27, v0
    v_mov_b32 v2, 0x3f803f80
    v_cmp_eq_u32 vcc, 16, v9
    v_cndmask_b32 v9, 0, v2, vcc
    v_mov_b32 v40, 0xdddddddd
    s_waitcnt lgkmcnt(15)
    v_mfma_f32_32x32x16_bf16 v[108:123], v[28:31], a[64:67], v[108:123]
    ds_read_b64_tr_b16 v[28:29], v16 offset:9280
    ds_read_b64_tr_b16 v[30:31], v16 offset:10048
    s_waitcnt lgkmcnt(15)
    v_mfma_f32_32x32x16_bf16 v[76:91], v[52:55], a[68:71], v[76:91]
    s_waitcnt lgkmcnt(14)
    v_mfma_f32_32x32x16_bf16 v[92:107], v[56:59], a[68:71], v[92:107]
    s_waitcnt vmcnt(6) lgkmcnt(0)
    s_mov_b32 s80, 400000
L_sr_16:
    s_waitcnt vmcnt(0)
    v_cmp_ne_u32 vcc, 1, v125
    s_sub_u32 s80, s80, 1
    s_nop 3
    s_cselect_b64 vcc, 0, vcc
    s_mov_b64 exec, vcc
    buffer_load_dword v125, v126, s[24:27], 0 offen sc1
    s_mov_b64 exec, -1
    s_cmp_lg_u64 vcc, 0
    s_cbranch_scc1 L_sr_16
    s_barrier
    ds_read_b64_tr_b16 v[52:53], v16 offset:28672
    ds_read_b64_tr_b16 v[54:55], v16 offset:29440
    ds_read_b64_tr_b16 v[56:57], v16 offset:28704
    ds_read_b64_tr_b16 v[58:59], v16 offset:29472
    s_lshl_b32 s76, s44, 16
    s_lshl_b32 s77, s45, 3
    s_add_u32 s77, s77, s3
    s_lshl_b32 s77, s77, 10
    s_add_u32 s77, s77, s76
    buffer_load_dwordx4 v[12:15], v1, s[24:27], s77 offen sc1
    s_and_b32 s77, s3, 3
    s_lshl_b32 s77, s77, 10
    s_lshr_b32 s78, s3, 2
    s_lshl_b32 s88, s3, 10
    s_lshl_b32 s78, s78, 21
    s_add_u32 s78, s78, 2097152
    s_add_u32 s78, s78, s76
    s_add_u32 s87, s78, s77
    v_mfma_f32_32x32x16_bf16 v[108:123], v[68:71], a[68:71], v[108:123]
    ds_read_b64_tr_b16 v[68:69], v16 offset:28736
    ds_read_b64_tr_b16 v[70:71], v16 offset:29504
    s_add_u32 m0, s88, 28672
    s_nop 0
    buffer_load_dwordx4 v1, s[24:27], s87 offen sc1 lds
    s_add_u32 s87, s87, 4096
    v_mfma_f32_32x32x16_bf16 v[76:91], v[72:75], a[72:75], v[76:91]
    ds_read_b64_tr_b16 v[72:73], v16 offset:31744
    ds_read_b64_tr_b16 v[74:75], v16 offset:32512
    s_add_u32 m0, s88, 36864
    s_nop 0
    buffer_load_dwordx4 v1, s[24:27], s87 offen sc1 lds
    s_add_u32 s87, s87, 4096
    v_mfma_f32_32x32x16_bf16 v[92:107], v[32:35], a[72:75], v[92:107]
    ds_read_b64_tr_b16 v[32:33], v16 offset:31776
    ds_read_b64_tr_b16 v[34:35], v16 offset:32544
    s_add_u32 m0, s88, 45056
    s_nop 0
    buffer_load_dwordx4 v1, s[24:27], s87 offen sc1 lds
    s_add_u32 s87, s87, 4096
    v_mfma_f32_32x32x16_bf16 v[108:123], v[36:39], a[72:75], v[108:123]
    ds_read_b64_tr_b16 v[36:37], v16 offset:31808
    ds_read_b64_tr_b16 v[38:39], v16 offset:32576
    s_add_u32 m0, s88, 53248
    s_nop 0
    buffer_load_dwordx4 v1, s[24:27], s87 offen sc1 lds
    s_add_u32 s87, s87, 4096
    v_mfma_f32_32x32x16_bf16 v[76:91], v[20:23], a[76:79], v[76:91]
    ds_read_b64_tr_b16 v[20:21], v16 offset:34816
    ds_read_b64_tr_b16 v[22:23], v16 offset:35584
    s_add_u32 m0, s88, 61440
    s_nop 0
    buffer_load_dwordx4 v1, s[24:27], s87 offen sc1 lds
    s_add_u32 s87, s87, 4096
    v_mfma_f32_32x32x16_bf16 v[92:107], v[24:27], a[76:79], v[92:107]
    ds_read_b64_tr_b16 v[24:25], v16 offset:34848
    ds_read_b64_tr_b16 v[26:27], v16 offset:35616
    s_add_u32 m0, s88, 69632
    s_nop 0
    buffer_load_dwordx4 v1, s[24:27], s87 offen sc1 lds
    s_add_u32 s87, s87, 4096
    v_mfma_f32_32x32x16_bf16 v[108:123], v[28:31], a[76:79], v[108:123]
    ds_read_b64_tr_b16 v[28:29], v16 offset:34880
    ds_read_b64_tr_b16 v[30:31], v16 offset:35648
    s_add_u32 m0, s88, 77824
    s_nop 0
    buffer_load_dwordx4 v1, s[24:27], s87 offen sc1 lds
    s_add_u32 s87, s87, 4096
    s_waitcnt lgkmcnt(15)
    v_mfma_f32_32x32x16_bf16 v[76:91], v[52:55], a[80:83], v[76:91]
    ds_read_b64_tr_b16 v[52:53], v16 offset:37888
    ds_read_b64_tr_b16 v[54:55], v16 offset:38656
    s_waitcnt lgkmcnt(15)
    v_mfma_f32_32x32x16_bf16 v[92:107], v[56:59], a[80:83], v[92:107]
    ds_read_b64_tr_b16 v[56:57], v16 offset:37920
    ds_read_b64_tr_b16 v[58:59], v16 offset:38688
    s_waitcnt lgkmcnt(15)
    v_mfma_f32_32x32x16_bf16 v[108:123], v[68:71], a[80:83], v[108:123]
    ds_read_b64_tr_b16 v[68:69], v16 offset:37952
    ds_read_b64_tr_b16 v[70:71], v16 offset:38720
    s_waitcnt lgkmcnt(15)
    v_mfma_f32_32x32x16_bf16 v[76:91], v[72:75], a[84:87], v[76:91]
    s_waitcnt lgkmcnt(14)
    v_mfma_f32_32x32x16_bf16 v[92:107], v[32:35], a[84:87], v[92:107]
    s_waitcnt lgkmcnt(0)
    s_barrier
    ds_read_b64_tr_b16 v[72:73], v17 offset:0
    ds_read_b64_tr_b16 v[74:75], v17 offset:768
    ds_read_b64_tr_b16 v[32:33], v17 offset:3072
    ds_read_b64_tr_b16 v[34:35], v17 offset:3840
    s_add_u32 m0, s88, 86016
    s_nop 0
    buffer_load_dwordx4 v1, s[24:27], s87 offen sc1 lds
    s_add_u32 s87, s87, 4096
    v_mfma_f32_32x32x16_bf16 v[108:123], v[36:39], a[84:87], v[108:123]
    ds_read_b64_tr_b16 v[36:37], v17 offset:6144
    ds_read_b64_tr_b16 v[38:39], v17 offset:6912
    s_add_u32 m0, s88, 94208
    s_nop 0
    buffer_load_dwordx4 v1, s[24:27], s87 offen sc1 lds
    s_add_u32 s87, s87, 4096
    v_mfma_f32_32x32x16_bf16 v[76:91], v[20:23], a[88:91], v[76:91]
    ds_read_b64_tr_b16 v[20:21], v17 offset:9216
    ds_read_b64_tr_b16 v[22:23], v17 offset:9984
    s_add_u32 m0, s88, 102400
    s_nop 0
    buffer_load_dwordx4 v1, s[24:27], s87 offen sc1 lds
    s_add_u32 s87, s87, 20480
    v_mfma_f32_32x32x16_bf16 v[92:107], v[24:27], a[88:91], v[92:107]
    ds_read_b64_tr_b16 v[24:25], v18 offset:0
    ds_read_b64_tr_b16 v[26:27], v18 offset:768
    s_add_u32 m0, s88, 143360
    s_nop 0
    buffer_load_dwordx4 v1, s[24:27], s87 offen sc1 lds
    s_add_u32 s87, s87, 4096
    v_mfma_f32_32x32x16_bf16 v[108:123], v[28:31], a[88:91], v[108:123]
    ds_read_b64_tr_b16 v[28:29], v18 offset:3072
    ds_read_b64_tr_b16 v[30:31], v18 offset:3840
    s_add_u32 m0, s88, 151552
    s_nop 0
    buffer_load_dwordx4 v1, s[24:27], s87 offen sc1 lds
    s_sub_u32 s87, s87, 20480
    v_mfma_f32_32x32x16_bf16 v[76:91], v[52:55], a[92:95], v[76:91]
    ds_read_b64_tr_b16 v[52:53], v18 offset:6144
    ds_read_b64_tr_b16 v[54:55], v18 offset:6912
    v_mfma_f32_32x32x16_bf16 v[92:107], v[56:59], a[92:95], v[92:107]
    ds_read_b64_tr_b16 v[56:57], v18 offset:9216
    ds_read_b64_tr_b16 v[58:59], v18 offset:9984
    v_mfma_f32_32x32x16_bf16 v[108:123], v[68:71], a[92:95], v[108:123]
    ds_read_b64_tr_b16 v[68:69], v17 offset:32
    ds_read_b64_tr_b16 v[70:71], v17 offset:800
    s_waitcnt lgkmcnt(15)
    v_mfma_f32_32x32x16_bf16 v[76:91], v[72:75], a[96:99], v[76:91]
    ds_read_b64_tr_b16 v[72:73], v17 offset:3104
    ds_read_b64_tr_b16 v[74:75], v17 offset:3872
    s_waitcnt lgkmcnt(15)
    v_mfma_f32_32x32x16_bf16 v[76:91], v[32:35], a[100:103], v[76:91]
    ds_read_b64_tr_b16 v[32:33], v17 offset:6176
    ds_read_b64_tr_b16 v[34:35], v17 offset:6944
    s_waitcnt lgkmcnt(15)
    v_mfma_f32_32x32x16_bf16 v[76:91], v[36:39], a[104:107], v[76:91]
    ds_read_b64_tr_b16 v[36:37], v17 offset:9248
    ds_read_b64_tr_b16 v[38:39], v17 offset:10016
    s_waitcnt lgkmcnt(15)
    v_mfma_f32_32x32x16_bf16 v[76:91], v[20:23], a[108:111], v[76:91]
    ds_read_b64_tr_b16 v[20:21], v18 offset:32
    ds_read_b64_tr_b16 v[22:23], v18 offset:800
    s_waitcnt lgkmcnt(15)
    v_mfma_f32_32x32x16_bf16 v[76:91], v[24:27], a[112:115], v[76:91]
    ds_read_b64_tr_b16 v[24:25], v18 offset:3104
    ds_read_b64_tr_b16 v[26:27], v18 offset:3872
    s_waitcnt lgkmcnt(15)
    v_mfma_f32_32x32x16_bf16 v[76:91], v[28:31], a[116:119], v[76:91]
    ds_read_b64_tr_b16 v[28:29], v18 offset:6176
    ds_read_b64_tr_b16 v[30:31], v18 offset:6944
    s_waitcnt lgkmcnt(15)
    v_mfma_f32_32x32x16_bf16 v[76:91], v[52:55], a[120:123], v[76:91]
    ds_read_b64_tr_b16 v[52:53], v18 offset:9248
    ds_read_b64_tr_b16 v[54:55], v18 offset:10016
    s_waitcnt lgkmcnt(15)
    v_mfma_f32_32x32x16_bf16 v[76:91], v[56:59], a[124:127], v[76:91]
    ds_read_b64_tr_b16 v[56:57], v17 offset:64
    ds_read_b64_tr_b16 v[58:59], v17 offset:832
    s_waitcnt lgkmcnt(15)
    v_mfma_f32_32x32x16_bf16 v[92:107], v[68:71], a[96:99], v[92:107]
    ds_read_b64_tr_b16 v[68:69], v17 offset:3136
    ds_read_b64_tr_b16 v[70:71], v17 offset:3904
    s_waitcnt lgkmcnt(15)
    v_mfma_f32_32x32x16_bf16 v[92:107], v[72:75], a[100:103], v[92:107]
    ds_read_b64_tr_b16 v[72:73], v17 offset:6208
    ds_read_b64_tr_b16 v[74:75], v17 offset:6976
    s_nop 1
    v_mul_f32 v60, v76, v76
    v_mul_f32 v61, v77, v77
    v_mul_f32 v62, v78, v78
    v_mul_f32 v63, v79, v79
    v_mul_f32 v64, v80, v80
    v_mul_f32 v65, v81, v81
    v_mul_f32 v66, v82, v82
    v_mul_f32 v67, v83, v83
    v_fma_f32 v60, v60, v46, v44
    s_waitcnt lgkmcnt(15)
    v_mfma_f32_32x32x16_bf16 v[92:107], v[32:35], a[104:107], v[92:107]
    ds_read_b64_tr_b16 v[32:33], v17 offset:9280
    ds_read_b64_tr_b16 v[34:35], v17 offset:10048
    v_fma_f32 v61, v61, v46, v44
    v_fma_f32 v62, v62, v46, v44
    v_fma_f32 v63, v63, v46, v44
    v_fma_f32 v64, v64, v46, v44
    v_fma_f32 v65, v65, v46, v44
    v_fma_f32 v66, v66, v46, v44
    v_fma_f32 v67, v67, v46, v44
    v_mul_f32 v60, v60, v76
    v_mul_f32 v61, v61, v77
    s_waitcnt lgkmcnt(15)
    v_mfma_f32_32x32x16_bf16 v[92:107], v[36:39], a[108:111], v[92:107]
    ds_read_b64_tr_b16 v[36:37], v18 offset:64
    ds_read_b64_tr_b16 v[38:39], v18 offset:832
    v_mul_f32 v62, v62, v78
    v_mul_f32 v63, v63, v79
    v_mul_f32 v64, v64, v80
    v_mul_f32 v65, v65, v81
    v_mul_f32 v66, v66, v82
    v_mul_f32 v67, v67, v83
    v_exp_f32 v60, v60
    v_exp_f32 v61, v61
    v_exp_f32 v62, v62
    s_waitcnt lgkmcnt(15)
    v_mfma_f32_32x32x16_bf16 v[92:107], v[20:23], a[112:115], v[92:107]
    ds_read_b64_tr_b16 v[20:21], v18 offset:3136
    ds_read_b64_tr_b16 v[22:23], v18 offset:3904
    v_exp_f32 v63, v63
    v_exp_f32 v64, v64
    v_exp_f32 v65, v65
    v_exp_f32 v66, v66
    v_exp_f32 v67, v67
    v_add_f32 v60, 1.0, v60
    v_add_f32 v61, 1.0, v61
    v_add_f32 v62, 1.0, v62
    v_add_f32 v63, 1.0, v63
    s_waitcnt lgkmcnt(15)
    v_mfma_f32_32x32x16_bf16 v[92:107], v[24:27], a[116:119], v[92:107]
    ds_read_b64_tr_b16 v[24:25], v18 offset:6208
    ds_read_b64_tr_b16 v[26:27], v18 offset:6976
    v_add_f32 v64, 1.0, v64
    v_add_f32 v65, 1.0, v65
    v_add_f32 v66, 1.0, v66
    v_add_f32 v67, 1.0, v67
    v_rcp_f32 v60, v60
    v_rcp_f32 v61, v61
    v_rcp_f32 v62, v62
    v_rcp_f32 v63, v63
    v_rcp_f32 v64, v64
    s_waitcnt lgkmcnt(15)
    v_mfma_f32_32x32x16_bf16 v[92:107], v[28:31], a[120:123], v[92:107]
    ds_read_b64_tr_b16 v[28:29], v18 offset:9280
    ds_read_b64_tr_b16 v[30:31], v18 offset:10048
    v_rcp_f32 v65, v65
    v_rcp_f32 v66, v66
    v_rcp_f32 v67, v67
    v_mul_f32 v76, v76, v60
    v_mul_f32 v77, v77, v61
    v_mul_f32 v78, v78, v62
    v_mul_f32 v79, v79, v63
    v_mul_f32 v80, v80, v64
    s_waitcnt lgkmcnt(15)
    v_mfma_f32_32x32x16_bf16 v[92:107], v[52:55], a[124:127], v[92:107]
    v_mul_f32 v81, v81, v65
    v_mul_f32 v82, v82, v66
    v_mul_f32 v83, v83, v67
    v_mul_f32 v76, v76, v84
    v_mul_f32 v77, v77, v85
    v_mul_f32 v78, v78, v86
    v_mul_f32 v79, v79, v87
    v_mul_f32 v80, v80, v88
    s_waitcnt lgkmcnt(14)
    v_mfma_f32_32x32x16_bf16 v[108:123], v[56:59], a[96:99], v[108:123]
    v_mul_f32 v81, v81, v89
    v_mul_f32 v82, v82, v90
    v_mul_f32 v83, v83, v91
    v_cvt_pk_bf16_f32 v76, v76, v77
    v_cvt_pk_bf16_f32 v77, v78, v79
    v_cvt_pk_bf16_f32 v78, v80, v81
    v_cvt_pk_bf16_f32 v79, v82, v83
    s_cmp_lt_u32 s98, s99
    s_cselect_b32 s100, 0x1000000, s97
    s_add_u32 s98, s98, 1
    buffer_store_dwordx4 v[76:79], v1, s[24:27], s100 offen offset:0 sc1
    s_waitcnt lgkmcnt(12)
    v_mfma_f32_32x32x16_bf16 v[108:123], v[68:71], a[100:103], v[108:123]
    v_mul_f32 v60, v92, v92
    v_mul_f32 v61, v93, v93
    v_mul_f32 v62, v94, v94
    v_mul_f32 v63, v95, v95
    v_mul_f32 v64, v96, v96
    v_mul_f32 v65, v97, v97
    v_mul_f32 v66, v98, v98
    v_mul_f32 v67, v99, v99
    v_fma_f32 v60, v60, v46, v44
    v_fma_f32 v61, v61, v46, v44
    s_waitcnt lgkmcnt(10)
    v_mfma_f32_32x32x16_bf16 v[108:123], v[72:75], a[104:107], v[108:123]
    v_fma_f32 v62, v62, v46, v44
    v_fma_f32 v63, v63, v46, v44
    v_fma_f32 v64, v64, v46, v44
    v_fma_f32 v65, v65, v46, v44
    v_fma_f32 v66, v66, v46, v44
    v_fma_f32 v67, v67, v46, v44
    v_mul_f32 v60, v60, v92
    v_mul_f32 v61, v61, v93
    v_mul_f32 v62, v62, v94
    v_mul_f32 v63, v63, v95
    s_waitcnt lgkmcnt(8)
    v_mfma_f32_32x32x16_bf16 v[108:123], v[32:35], a[108:111], v[108:123]
    v_mul_f32 v64, v64, v96
    v_mul_f32 v65, v65, v97
    v_mul_f32 v66, v66, v98
    v_mul_f32 v67, v67, v99
    v_exp_f32 v60, v60
    v_exp_f32 v61, v61
    v_exp_f32 v62, v62
    v_exp_f32 v63, v63
    v_exp_f32 v64, v64
    v_exp_f32 v65, v65
    s_waitcnt lgkmcnt(6)
    v_mfma_f32_32x32x16_bf16 v[108:123], v[36:39], a[112:115], v[108:123]
    v_exp_f32 v66, v66
    v_exp_f32 v67, v67
    v_add_f32 v60, 1.0, v60
    v_add_f32 v61, 1.0, v61
    v_add_f32 v62, 1.0, v62
    v_add_f32 v63, 1.0, v63
    v_add_f32 v64, 1.0, v64
    v_add_f32 v65, 1.0, v65
    v_add_f32 v66, 1.0, v66
    v_add_f32 v67, 1.0, v67
    s_waitcnt lgkmcnt(4)
    v_mfma_f32_32x32x16_bf16 v[108:123], v[20:23], a[116:119], v[108:123]
    v_rcp_f32 v60, v60
    v_rcp_f32 v61, v61
    v_rcp_f32 v62, v62
    v_rcp_f32 v63, v63
    v_rcp_f32 v64, v64
    v_rcp_f32 v65, v65
    v_rcp_f32 v66, v66
    v_rcp_f32 v67, v67
    v_mul_f32 v92, v92, v60
    v_mul_f32 v93, v93, v61
    s_waitcnt lgkmcnt(2)
    v_mfma_f32_32x32x16_bf16 v[108:123], v[24:27], a[120:123], v[108:123]
    v_mul_f32 v94, v94, v62
    v_mul_f32 v95, v95, v63
    v_mul_f32 v96, v96, v64
    v_mul_f32 v97, v97, v65
    v_mul_f32 v98, v98, v66
    v_mul_f32 v99, v99, v67
    v_mul_f32 v92, v92, v100
    v_mul_f32 v93, v93, v101
    v_mul_f32 v94, v94, v102
    v_mul_f32 v95, v95, v103
    s_waitcnt lgkmcnt(0)
    v_mfma_f32_32x32x16_bf16 v[108:123], v[28:31], a[124:127], v[108:123]
    v_mul_f32 v96, v96, v104
    v_mul_f32 v97, v97, v105
    v_mul_f32 v98, v98, v106
    v_mul_f32 v99, v99, v107
    v_cvt_pk_bf16_f32 v92, v92, v93
    v_cvt_pk_bf16_f32 v93, v94, v95
    v_cvt_pk_bf16_f32 v94, v96, v97
    v_cvt_pk_bf16_f32 v95, v98, v99
    s_cmp_lt_u32 s98, s99
    s_cselect_b32 s100, 0x1000000, s97
    s_add_u32 s98, s98, 1
    buffer_store_dwordx4 v[92:95], v1, s[24:27], s100 offen offset:1024 sc1
    v_mul_f32 v60, v108, v108
    v_mul_f32 v61, v109, v109
    v_mul_f32 v62, v110, v110
    v_mul_f32 v63, v111, v111
    v_mul_f32 v64, v112, v112
    v_mul_f32 v65, v113, v113
    v_mul_f32 v66, v114, v114
    v_mul_f32 v67, v115, v115
    v_fma_f32 v60, v60, v46, v44
    v_fma_f32 v61, v61, v46, v44
    v_fma_f32 v62, v62, v46, v44
    v_fma_f32 v63, v63, v46, v44
    v_fma_f32 v64, v64, v46, v44
    v_fma_f32 v65, v65, v46, v44
    v_fma_f32 v66, v66, v46, v44
    v_fma_f32 v67, v67, v46, v44
    v_mul_f32 v60, v60, v108
    v_mul_f32 v61, v61, v109
    v_mul_f32 v62, v62, v110
    v_mul_f32 v63, v63, v111
    v_mul_f32 v64, v64, v112
    v_mul_f32 v65, v65, v113
    v_mul_f32 v66, v66, v114
    v_mul_f32 v67, v67, v115
    v_exp_f32 v60, v60
    v_exp_f32 v61, v61
    v_exp_f32 v62, v62
    v_exp_f32 v63, v63
    v_exp_f32 v64, v64
    v_exp_f32 v65, v65
    v_exp_f32 v66, v66
    v_exp_f32 v67, v67
    v_add_f32 v60, 1.0, v60
    v_add_f32 v61, 1.0, v61
    v_add_f32 v62, 1.0, v62
    v_add_f32 v63, 1.0, v63
    v_add_f32 v64, 1.0, v64
    v_add_f32 v65, 1.0, v65
    v_add_f32 v66, 1.0, v66
    v_add_f32 v67, 1.0, v67
    v_rcp_f32 v60, v60
    v_rcp_f32 v61, v61
    v_rcp_f32 v62, v62
    v_rcp_f32 v63, v63
    v_rcp_f32 v64, v64
    v_rcp_f32 v65, v65
    v_rcp_f32 v66, v66
    v_rcp_f32 v67, v67
    v_mul_f32 v108, v108, v60
    v_mul_f32 v109, v109, v61
    v_mul_f32 v110, v110, v62
    v_mul_f32 v111, v111, v63
    v_mul_f32 v112, v112, v64
    v_mul_f32 v113, v113, v65
    v_mul_f32 v114, v114, v66
    v_mul_f32 v115, v115, v67
    v_mul_f32 v108, v108, v116
    v_mul_f32 v109, v109, v117
    v_mul_f32 v110, v110, v118
    v_mul_f32 v111, v111, v119
    v_mul_f32 v112, v112, v120
    v_mul_f32 v113, v113, v121
    v_mul_f32 v114, v114, v122
    v_mul_f32 v115, v115, v123
    v_cvt_pk_bf16_f32 v108, v108, v109
    v_cvt_pk_bf16_f32 v109, v110, v111
    v_cvt_pk_bf16_f32 v110, v112, v113
    v_cvt_pk_bf16_f32 v111, v114, v115
    s_cmp_lt_u32 s98, s99
    s_cselect_b32 s100, 0x1000000, s97
    s_add_u32 s98, s98, 1
    buffer_store_dwordx4 v[108:111], v1, s[24:27], s100 offen offset:2048 sc1
L_att:
    s_waitcnt vmcnt(13)
    s_barrier
    ds_read_b128 v[16:19], v41 offset:0
    ds_read_b128 v[20:23], v41 offset:1024
    v_mov_b32 v24, v9
    v_mov_b32 v25, v9
    v_mov_b32 v26, v9
    v_mov_b32 v27, v9
    v_mov_b32 v28, v9
    v_mov_b32 v29, v9
    v_mov_b32 v30, v9
    v_mov_b32 v31, v9
    v_mov_b32 v32, v9
    v_mov_b32 v33, v9
    v_mov_b32 v34, v9
    v_mov_b32 v35, v9
    v_mov_b32 v36, v9
    v_mov_b32 v37, v9
    v_mov_b32 v38, v9
    v_mov_b32 v39, v9
    s_mov_b64 exec, s[40:41]
    ds_read_b128 v[24:27], v3 offset:0
    ds_read_b128 v[28:31], v3 offset:512
    s_mov_b64 exec, -1
    s_waitcnt lgkmcnt(3)
    v_mfma_f32_32x32x16_bf16 v[64:79], v[16:19], v[12:15], 0
    v_mov_b32 v48, 0
    v_mov_b32 v49, 0
    v_mov_b32 v50, 0
    v_mov_b32 v51, 0
    v_mov_b32 v52, 0
    v_mov_b32 v53, 0
    v_mov_b32 v54, 0
    v_mov_b32 v55, 0
    v_mov_b32 v56, 0
    v_mov_b32 v57, 0
    v_mov_b32 v58, 0
    v_mov_b32 v59, 0
    v_mov_b32 v60, 0
    v_mov_b32 v61, 0
    v_mov_b32 v62, 0
    v_mov_b32 v63, 0
    v_exp_f32 v64, v64
    v_exp_f32 v65, v65
    v_exp_f32 v66, v66
    v_exp_f32 v67, v67
    v_exp_f32 v68, v68
    v_exp_f32 v69, v69
    s_waitcnt lgkmcnt(2)
    v_mfma_f32_32x32x16_bf16 v[80:95], v[20:23], v[12:15], 0
    ds_read_b128 v[16:19], v41 offset:2048
    s_setprio 3
    v_exp_f32 v70, v70
    s_add_u32 m0, s88, 110592
    s_nop 0
    buffer_load_dwordx4 v1, s[24:27], s87 offen sc1 lds
    s_add_u32 s87, s87, 4096
    s_mov_b64 exec, s[40:41]
    ds_read_b128 v[32:35], v3 offset:1024
    ds_read_b128 v[36:39], v3 offset:1536
    s_mov_b64 exec, -1
    v_exp_f32 v71, v71
    v_exp_f32 v72, v72
    v_exp_f32 v73, v73
    v_exp_f32 v74, v74
    v_exp_f32 v75, v75
    v_exp_f32 v76, v76
    v_exp_f32 v77, v77
    v_exp_f32 v78, v78
    v_exp_f32 v79, v79
    s_waitcnt lgkmcnt(3)
    v_smfmac_f32_32x32x32_bf16 v[48:63], v[24:27], v[64:71], v40
    v_exp_f32 v80, v80
    v_exp_f32 v81, v81
    v_smfmac_f32_32x32x32_bf16 v[48:63], v[28:31], v[72:79], v40
    v_exp_f32 v82, v82
    v_exp_f32 v83, v83
    v_exp_f32 v84, v84
    v_exp_f32 v85, v85
    s_waitcnt lgkmcnt(2)
    v_mfma_f32_32x32x16_bf16 v[64:79], v[16:19], v[12:15], 0
    ds_read_b128 v[20:23], v41 offset:3072
    s_setprio 2
    v_exp_f32 v86, v86
    s_add_u32 m0, s88, 118784
    s_nop 0
    buffer_load_dwordx4 v1, s[24:27], s87 offen sc1 lds
    s_add_u32 s87, s87, 4096
    s_mov_b64 exec, s[40:41]
    ds_read_b128 v[24:27], v3 offset:2048
    ds_read_b128 v[28:31], v3 offset:2560
    s_mov_b64 exec, -1
    v_exp_f32 v87, v87
    v_exp_f32 v88, v88
    v_exp_f32 v89, v89
    v_exp_f32 v90, v90
    v_exp_f32 v91, v91
    v_exp_f32 v92, v92
    v_exp_f32 v93, v93
    v_exp_f32 v94, v94
    v_exp_f32 v95, v95
    s_waitcnt lgkmcnt(3)
    v_smfmac_f32_32x32x32_bf16 v[48:63], v[32:35], v[80:87], v40
    v_exp_f32 v64, v64
    v_exp_f32 v65, v65
    v_smfmac_f32_32x32x32_bf16 v[48:63], v[36:39], v[88:95], v40
    v_exp_f32 v66, v66
    v_exp_f32 v67, v67
    v_exp_f32 v68, v68
    v_exp_f32 v69, v69
    s_waitcnt lgkmcnt(2)
    v_mfma_f32_32x32x16_bf16 v[80:95], v[20:23], v[12:15], 0
    ds_read_b128 v[16:19], v41 offset:8192
    s_setprio 1
    v_exp_f32 v70, v70
    s_add_u32 m0, s88, 126976
    s_nop 0
    buffer_load_dwordx4 v1, s[24:27], s87 offen sc1 lds
    s_add_u32 s87, s87, 4096
    s_mov_b64 exec, s[40:41]
    ds_read_b128 v[32:35], v3 offset:3072
    ds_read_b128 v[36:39], v3 offset:3584
    s_mov_b64 exec, -1
    v_exp_f32 v71, v71
    v_exp_f32 v72, v72
    v_exp_f32 v73, v73
    v_exp_f32 v74, v74
    v_exp_f32 v75, v75
    v_exp_f32 v76, v76
    v_exp_f32 v77, v77
    v_exp_f32 v78, v78
    v_exp_f32 v79, v79
    s_waitcnt lgkmcnt(3)
    v_smfmac_f32_32x32x32_bf16 v[48:63], v[24:27], v[64:71], v40
    v_exp_f32 v80, v80
    v_exp_f32 v81, v81
    v_smfmac_f32_32x32x32_bf16 v[48:63], v[28:31], v[72:79], v40
    v_exp_f32 v82, v82
    v_exp_f32 v83, v83
    v_exp_f32 v84, v84
    v_exp_f32 v85, v85
    s_waitcnt lgkmcnt(2)
    v_mfma_f32_32x32x16_bf16 v[64:79], v[16:19], v[12:15], 0
    ds_read_b128 v[20:23], v41 offset:9216
    s_setprio 0
    v_exp_f32 v86, v86
    s_add_u32 m0, s88, 135168
    s_nop 0
    buffer_load_dwordx4 v1, s[24:27], s87 offen sc1 lds
    s_add_u32 s87, s87, 4096
    s_mov_b64 exec, s[40:41]
    ds_read_b128 v[24:27], v3 offset:8192
    ds_read_b128 v[28:31], v3 offset:8704
    s_mov_b64 exec, -1
    v_exp_f32 v87, v87
    v_exp_f32 v88, v88
    v_exp_f32 v89, v89
    v_exp_f32 v90, v90
    v_exp_f32 v91, v91
    v_exp_f32 v92, v92
    v_exp_f32 v93, v93
    v_exp_f32 v94, v94
    v_exp_f32 v95, v95
    s_waitcnt lgkmcnt(3)
    v_smfmac_f32_32x32x32_bf16 v[48:63], v[32:35], v[80:87], v40
    s_waitcnt vmcnt(4)
    s_barrier
    v_mov_b32 v124, 0
    v_mov_b32 v125, 1
    s_cmp_eq_u32 s3, 0
    s_cselect_b64 exec, 1, 0
    buffer_store_dword v125, v124, s[24:27], s86 offen sc1
    s_mov_b64 exec, -1
    v_exp_f32 v64, v64
    v_exp_f32 v65, v65
    v_smfmac_f32_32x32x32_bf16 v[48:63], v[36:39], v[88:95], v40
    v_exp_f32 v66, v66
    v_exp_f32 v67, v67
    v_exp_f32 v68, v68
    v_exp_f32 v69, v69
    s_waitcnt lgkmcnt(2)
    v_mfma_f32_32x32x16_bf16 v[80:95], v[20:23], v[12:15], 0
    ds_read_b128 v[16:19], v41 offset:10240
    s_setprio 3
    v_exp_f32 v70, v70
    s_mov_b64 exec, s[40:41]
    ds_read_b128 v[32:35], v3 offset:9216
    ds_read_b128 v[36:39], v3 offset:9728
    s_mov_b64 exec, -1
    v_exp_f32 v71, v71
    v_exp_f32 v72, v72
    v_exp_f32 v73, v73
    v_exp_f32 v74, v74
    v_exp_f32 v75, v75
    v_exp_f32 v76, v76
    v_exp_f32 v77, v77
    v_exp_f32 v78, v78
    v_exp_f32 v79, v79
    s_waitcnt lgkmcnt(3)
    v_smfmac_f32_32x32x32_bf16 v[48:63], v[24:27], v[64:71], v40
    v_exp_f32 v80, v80
    v_exp_f32 v81, v81
    v_smfmac_f32_32x32x32_bf16 v[48:63], v[28:31], v[72:79], v40
    v_exp_f32 v82, v82
    v_exp_f32 v83, v83
    v_exp_f32 v84, v84
    v_exp_f32 v85, v85
    s_waitcnt lgkmcnt(2)
    v_mfma_f32_32x32x16_bf16 v[64:79], v[16:19], v[12:15], 0
    ds_read_b128 v[20:23], v41 offset:11264
    s_setprio 2
    v_exp_f32 v86, v86
    s_mov_b64 exec, s[40:41]
    ds_read_b128 v[24:27], v3 offset:10240
    ds_read_b128 v[28:31], v3 offset:10752
    s_mov_b64 exec, -1
    v_exp_f32 v87, v87
    v_exp_f32 v88, v88
    v_exp_f32 v89, v89
    v_exp_f32 v90, v90
    v_exp_f32 v91, v91
    v_exp_f32 v92, v92
    v_exp_f32 v93, v93
    v_exp_f32 v94, v94
    v_exp_f32 v95, v95
    s_waitcnt lgkmcnt(3)
    v_smfmac_f32_32x32x32_bf16 v[48:63], v[32:35], v[80:87], v40
    v_exp_f32 v64, v64
    v_exp_f32 v65, v65
    v_smfmac_f32_32x32x32_bf16 v[48:63], v[36:39], v[88:95], v40
    v_exp_f32 v66, v66
    v_exp_f32 v67, v67
    v_exp_f32 v68, v68
    v_exp_f32 v69, v69
    s_waitcnt lgkmcnt(2)
    v_mfma_f32_32x32x16_bf16 v[80:95], v[20:23], v[12:15], 0
    ds_read_b128 v[16:19], v41 offset:16384
    s_setprio 1
    v_exp_f32 v70, v70
    s_mov_b64 exec, s[40:41]
    ds_read_b128 v[32:35], v3 offset:11264
    ds_read_b128 v[36:39], v3 offset:11776
    s_mov_b64 exec, -1
    v_exp_f32 v71, v71
    v_exp_f32 v72, v72
    v_exp_f32 v73, v73
    v_exp_f32 v74, v74
    v_exp_f32 v75, v75
    v_exp_f32 v76, v76
    v_exp_f32 v77, v77
    v_exp_f32 v78, v78
    v_exp_f32 v79, v79
    s_waitcnt lgkmcnt(3)
    v_smfmac_f32_32x32x32_bf16 v[48:63], v[24:27], v[64:71], v40
    v_exp_f32 v80, v80
    v_exp_f32 v81, v81
    v_smfmac_f32_32x32x32_bf16 v[48:63], v[28:31], v[72:79], v40
    v_exp_f32 v82, v82
    v_exp_f32 v83, v83
    v_exp_f32 v84, v84
    v_exp_f32 v85, v85
    s_waitcnt lgkmcnt(2)
    v_mfma_f32_32x32x16_bf16 v[64:79], v[16:19], v[12:15], 0
    ds_read_b128 v[20:23], v41 offset:17408
    s_setprio 0
    v_exp_f32 v86, v86
    s_mov_b64 exec, s[40:41]
    ds_read_b128 v[24:27], v3 offset:16384
    ds_read_b128 v[28:31], v3 offset:16896
    s_mov_b64 exec, -1
    v_exp_f32 v87, v87
    v_exp_f32 v88, v88
    v_exp_f32 v89, v89
    v_exp_f32 v90, v90
    v_exp_f32 v91, v91
    v_exp_f32 v92, v92
    v_exp_f32 v93, v93
    v_exp_f32 v94, v94
    v_exp_f32 v95, v95
    s_waitcnt lgkmcnt(3)
    v_smfmac_f32_32x32x32_bf16 v[48:63], v[32:35], v[80:87], v40
    s_barrier
    v_exp_f32 v64, v64
    v_exp_f32 v65, v65
    v_smfmac_f32_32x32x32_bf16 v[48:63], v[36:39], v[88:95], v40
    v_exp_f32 v66, v66
    v_exp_f32 v67, v67
    v_exp_f32 v68, v68
    v_exp_f32 v69, v69
    s_waitcnt lgkmcnt(2)
    v_mfma_f32_32x32x16_bf16 v[80:95], v[20:23], v[12:15], 0
    ds_read_b128 v[16:19], v41 offset:18432
    s_setprio 3
    v_exp_f32 v70, v70
    s_add_u32 s76, s72, 0
    s_add_u32 m0, s73, 0
    s_nop 0
    buffer_load_dwordx4 v8, s[16:19], s76 offen lds
    s_mov_b64 exec, s[40:41]
    ds_read_b128 v[32:35], v3 offset:17408
    ds_read_b128 v[36:39], v3 offset:17920
    s_mov_b64 exec, -1
    v_exp_f32 v71, v71
    v_exp_f32 v72, v72
    v_exp_f32 v73, v73
    v_exp_f32 v74, v74
    v_exp_f32 v75, v75
    v_exp_f32 v76, v76
    v_exp_f32 v77, v77
    v_exp_f32 v78, v78
    v_exp_f32 v79, v79
    s_waitcnt lgkmcnt(3)
    v_smfmac_f32_32x32x32_bf16 v[48:63], v[24:27], v[64:71], v40
    v_exp_f32 v80, v80
    v_exp_f32 v81, v81
    v_smfmac_f32_32x32x32_bf16 v[48:63], v[28:31], v[72:79], v40
    v_exp_f32 v82, v82
    v_exp_f32 v83, v83
    v_exp_f32 v84, v84
    v_exp_f32 v85, v85
    s_waitcnt lgkmcnt(2)
    v_mfma_f32_32x32x16_bf16 v[64:79], v[16:19], v[12:15], 0
    ds_read_b128 v[20:23], v41 offset:19456
    s_setprio 2
    v_exp_f32 v86, v86
    s_add_u32 s76, s72, 8192
    s_add_u32 m0, s73, 1024
    s_nop 0
    buffer_load_dwordx4 v8, s[16:19], s76 offen lds
    s_mov_b64 exec, s[40:41]
    ds_read_b128 v[24:27], v3 offset:18432
    ds_read_b128 v[28:31], v3 offset:18944
    s_mov_b64 exec, -1
    v_exp_f32 v87, v87
    v_exp_f32 v88, v88
    v_exp_f32 v89, v89
    v_exp_f32 v90, v90
    v_exp_f32 v91, v91
    v_exp_f32 v92, v92
    v_exp_f32 v93, v93
    v_exp_f32 v94, v94
    v_exp_f32 v95, v95
    s_waitcnt lgkmcnt(3)
    v_smfmac_f32_32x32x32_bf16 v[48:63], v[32:35], v[80:87], v40
    v_exp_f32 v64, v64
    v_exp_f32 v65, v65
    v_smfmac_f32_32x32x32_bf16 v[48:63], v[36:39], v[88:95], v40
    v_exp_f32 v66, v66
    v_exp_f32 v67, v67
    v_exp_f32 v68, v68
    v_exp_f32 v69, v69
    s_waitcnt lgkmcnt(2)
    v_mfma_f32_32x32x16_bf16 v[80:95], v[20:23], v[12:15], 0
    ds_read_b128 v[16:19], v41 offset:24576
    s_setprio 1
    v_exp_f32 v70, v70
    s_mov_b64 exec, s[40:41]
    ds_read_b128 v[32:35], v3 offset:19456
    ds_read_b128 v[36:39], v3 offset:19968
    s_mov_b64 exec, -1
    v_exp_f32 v71, v71
    v_exp_f32 v72, v72
    v_exp_f32 v73, v73
    v_exp_f32 v74, v74
    v_exp_f32 v75, v75
    v_exp_f32 v76, v76
    v_exp_f32 v77, v77
    v_exp_f32 v78, v78
    v_exp_f32 v79, v79
    s_waitcnt lgkmcnt(3)
    v_smfmac_f32_32x32x32_bf16 v[48:63], v[24:27], v[64:71], v40
    v_exp_f32 v80, v80
    v_exp_f32 v81, v81
    v_smfmac_f32_32x32x32_bf16 v[48:63], v[28:31], v[72:79], v40
    v_exp_f32 v82, v82
    v_exp_f32 v83, v83
    v_exp_f32 v84, v84
    v_exp_f32 v85, v85
    s_waitcnt lgkmcnt(2)
    v_mfma_f32_32x32x16_bf16 v[64:79], v[16:19], v[12:15], 0
    ds_read_b128 v[20:23], v41 offset:25600
    s_setprio 0
    v_exp_f32 v86, v86
    s_mov_b64 exec, s[40:41]
    ds_read_b128 v[24:27], v3 offset:24576
    ds_read_b128 v[28:31], v3 offset:25088
    s_mov_b64 exec, -1
    v_exp_f32 v87, v87
    v_exp_f32 v88, v88
    v_exp_f32 v89, v89
    v_exp_f32 v90, v90
    v_exp_f32 v91, v91
    v_exp_f32 v92, v92
    v_exp_f32 v93, v93
    v_exp_f32 v94, v94
    v_exp_f32 v95, v95
    s_waitcnt lgkmcnt(3)
    v_smfmac_f32_32x32x32_bf16 v[48:63], v[32:35], v[80:87], v40
    s_barrier
    v_mov_b32 v125, 1
    s_cmp_eq_u32 s3, 0
    s_cselect_b64 exec, -1, 0
    buffer_load_dword v125, v10, s[24:27], 0 offen sc1
    s_mov_b64 exec, -1
    v_exp_f32 v64, v64
    v_exp_f32 v65, v65
    v_smfmac_f32_32x32x32_bf16 v[48:63], v[36:39], v[88:95], v40
    v_exp_f32 v66, v66
    v_exp_f32 v67, v67
    v_exp_f32 v68, v68
    v_exp_f32 v69, v69
    s_waitcnt lgkmcnt(2)
    v_mfma_f32_32x32x16_bf16 v[80:95], v[20:23], v[12:15], 0
    ds_read_b128 v[16:19], v41 offset:26624
    s_setprio 3
    v_exp_f32 v70, v70
    s_add_u32 s76, s72, 131072
    s_add_u32 m0, s73, 16384
    s_nop 0
    buffer_load_dwordx4 v8, s[16:19], s76 offen lds
    s_mov_b64 exec, s[40:41]
    ds_read_b128 v[32:35], v3 offset:25600
    ds_read_b128 v[36:39], v3 offset:26112
    s_mov_b64 exec, -1
    v_exp_f32 v71, v71
    v_exp_f32 v72, v72
    v_exp_f32 v73, v73
    v_exp_f32 v74, v74
    v_exp_f32 v75, v75
    v_exp_f32 v76, v76
    v_exp_f32 v77, v77
    v_exp_f32 v78, v78
    v_exp_f32 v79, v79
    s_waitcnt lgkmcnt(3)
    v_smfmac_f32_32x32x32_bf16 v[48:63], v[24:27], v[64:71], v40
    v_exp_f32 v80, v80
    v_exp_f32 v81, v81
    v_smfmac_f32_32x32x32_bf16 v[48:63], v[28:31], v[72:79], v40
    v_exp_f32 v82, v82
    v_exp_f32 v83, v83
    v_exp_f32 v84, v84
    v_exp_f32 v85, v85
    s_waitcnt lgkmcnt(2)
    v_mfma_f32_32x32x16_bf16 v[64:79], v[16:19], v[12:15], 0
    ds_read_b128 v[20:23], v41 offset:27648
    s_setprio 2
    v_exp_f32 v86, v86
    s_add_u32 s76, s72, 139264
    s_add_u32 m0, s73, 17408
    s_nop 0
    buffer_load_dwordx4 v8, s[16:19], s76 offen lds
    s_mov_b64 exec, s[40:41]
    ds_read_b128 v[24:27], v3 offset:26624
    ds_read_b128 v[28:31], v3 offset:27136
    s_mov_b64 exec, -1
    v_exp_f32 v87, v87
    v_exp_f32 v88, v88
    v_exp_f32 v89, v89
    v_exp_f32 v90, v90
    v_exp_f32 v91, v91
    v_exp_f32 v92, v92
    v_exp_f32 v93, v93
    v_exp_f32 v94, v94
    v_exp_f32 v95, v95
    s_waitcnt lgkmcnt(3)
    v_smfmac_f32_32x32x32_bf16 v[48:63], v[32:35], v[80:87], v40
    v_exp_f32 v64, v64
    v_exp_f32 v65, v65
    v_smfmac_f32_32x32x32_bf16 v[48:63], v[36:39], v[88:95], v40
    v_exp_f32 v66, v66
    v_exp_f32 v67, v67
    v_exp_f32 v68, v68
    v_exp_f32 v69, v69
    s_waitcnt lgkmcnt(2)
    v_mfma_f32_32x32x16_bf16 v[80:95], v[20:23], v[12:15], 0
    ds_read_b128 v[16:19], v41 offset:32768
    s_setprio 1
    v_exp_f32 v70, v70
    s_mov_b64 exec, s[40:41]
    ds_read_b128 v[32:35], v3 offset:27648
    ds_read_b128 v[36:39], v3 offset:28160
    s_mov_b64 exec, -1
    v_exp_f32 v71, v71
    v_exp_f32 v72, v72
    v_exp_f32 v73, v73
    v_exp_f32 v74, v74
    v_exp_f32 v75, v75
    v_exp_f32 v76, v76
    v_exp_f32 v77, v77
    v_exp_f32 v78, v78
    v_exp_f32 v79, v79
    s_waitcnt lgkmcnt(3)
    v_smfmac_f32_32x32x32_bf16 v[48:63], v[24:27], v[64:71], v40
    v_exp_f32 v80, v80
    v_exp_f32 v81, v81
    v_smfmac_f32_32x32x32_bf16 v[48:63], v[28:31], v[72:79], v40
    v_exp_f32 v82, v82
    v_exp_f32 v83, v83
    v_exp_f32 v84, v84
    v_exp_f32 v85, v85
    s_waitcnt lgkmcnt(2)
    v_mfma_f32_32x32x16_bf16 v[64:79], v[16:19], v[12:15], 0
    ds_read_b128 v[20:23], v41 offset:33792
    s_setprio 0
    v_exp_f32 v86, v86
    s_mov_b64 exec, s[40:41]
    ds_read_b128 v[24:27], v3 offset:32768
    ds_read_b128 v[28:31], v3 offset:33280
    s_mov_b64 exec, -1
    v_exp_f32 v87, v87
    v_exp_f32 v88, v88
    v_exp_f32 v89, v89
    v_exp_f32 v90, v90
    v_exp_f32 v91, v91
    v_exp_f32 v92, v92
    v_exp_f32 v93, v93
    v_exp_f32 v94, v94
    v_exp_f32 v95, v95
    s_waitcnt lgkmcnt(3)
    v_smfmac_f32_32x32x32_bf16 v[48:63], v[32:35], v[80:87], v40
    s_mov_b32 s80, 400000
L_sr_17:
    s_waitcnt vmcnt(0)
    v_cmp_ne_u32 vcc, 1, v125
    s_sub_u32 s80, s80, 1
    s_nop 3
    s_cselect_b64 vcc, 0, vcc
    s_mov_b64 exec, vcc
    buffer_load_dword v125, v10, s[24:27], 0 offen sc1
    s_mov_b64 exec, -1
    s_cmp_lg_u64 vcc, 0
    s_cbranch_scc1 L_sr_17
    s_barrier
    v_exp_f32 v64, v64
    v_exp_f32 v65, v65
    v_smfmac_f32_32x32x32_bf16 v[48:63], v[36:39], v[88:95], v40
    v_exp_f32 v66, v66
    v_exp_f32 v67, v67
    v_exp_f32 v68, v68
    v_exp_f32 v69, v69
    s_waitcnt lgkmcnt(2)
    v_mfma_f32_32x32x16_bf16 v[80:95], v[20:23], v[12:15], 0
    ds_read_b128 v[16:19], v41 offset:34816
    s_setprio 3
    v_exp_f32 v70, v70
    buffer_load_dwordx4 a[32:35], v1, s[24:27], s74 offen offset:0 sc1
    s_mov_b64 exec, s[40:41]
    ds_read_b128 v[32:35], v3 offset:33792
    ds_read_b128 v[36:39], v3 offset:34304
    s_mov_b64 exec, -1
    v_exp_f32 v71, v71
    v_exp_f32 v72, v72
    v_exp_f32 v73, v73
    v_exp_f32 v74, v74
    v_exp_f32 v75, v75
    v_exp_f32 v76, v76
    v_exp_f32 v77, v77
    v_exp_f32 v78, v78
    v_exp_f32 v79, v79
    s_waitcnt lgkmcnt(3)
    v_smfmac_f32_32x32x32_bf16 v[48:63], v[24:27], v[64:71], v40
    v_exp_f32 v80, v80
    v_exp_f32 v81, v81
    v_smfmac_f32_32x32x32_bf16 v[48:63], v[28:31], v[72:79], v40
    v_exp_f32 v82, v82
    v_exp_f32 v83, v83
    v_exp_f32 v84, v84
    v_exp_f32 v85, v85
    s_waitcnt lgkmcnt(2)
    v_mfma_f32_32x32x16_bf16 v[64:79], v[16:19], v[12:15], 0
    ds_read_b128 v[20:23], v41 offset:35840
    s_setprio 2
    v_exp_f32 v86, v86
    buffer_load_dwordx4 a[36:39], v1, s[24:27], s74 offen offset:1024 sc1
    s_add_u32 s74, s74, 8192
    s_mov_b64 exec, s[40:41]
    ds_read_b128 v[24:27], v3 offset:34816
    ds_read_b128 v[28:31], v3 offset:35328
    s_mov_b64 exec, -1
    v_exp_f32 v87, v87
    v_exp_f32 v88, v88
    v_exp_f32 v89, v89
    v_exp_f32 v90, v90
    v_exp_f32 v91, v91
    v_exp_f32 v92, v92
    v_exp_f32 v93, v93
    v_exp_f32 v94, v94
    v_exp_f32 v95, v95
    s_waitcnt lgkmcnt(3)
    v_smfmac_f32_32x32x32_bf16 v[48:63], v[32:35], v[80:87], v40
    v_exp_f32 v64, v64
    v_exp_f32 v65, v65
    v_smfmac_f32_32x32x32_bf16 v[48:63], v[36:39], v[88:95], v40
    v_exp_f32 v66, v66
    v_exp_f32 v67, v67
    v_exp_f32 v68, v68
    v_exp_f32 v69, v69
    s_waitcnt lgkmcnt(2)
    v_mfma_f32_32x32x16_bf16 v[80:95], v[20:23], v[12:15], 0
    ds_read_b128 v[16:19], v41 offset:40960
    s_setprio 1
    v_exp_f32 v70, v70
    s_add_u32 s76, s72, 262144
    s_add_u32 m0, s73, 32768
    s_nop 0
    buffer_load_dwordx4 v8, s[16:19], s76 offen lds
    s_mov_b64 exec, s[40:41]
    ds_read_b128 v[32:35], v3 offset:35840
    ds_read_b128 v[36:39], v3 offset:36352
    s_mov_b64 exec, -1
    v_exp_f32 v71, v71
    v_exp_f32 v72, v72
    v_exp_f32 v73, v73
    v_exp_f32 v74, v74
    v_exp_f32 v75, v75
    v_exp_f32 v76, v76
    v_exp_f32 v77, v77
    v_exp_f32 v78, v78
    v_exp_f32 v79, v79
    s_waitcnt lgkmcnt(3)
    v_smfmac_f32_32x32x32_bf16 v[48:63], v[24:27], v[64:71], v40
    v_exp_f32 v80, v80
    v_exp_f32 v81, v81
    v_smfmac_f32_32x32x32_bf16 v[48:63], v[28:31], v[72:79], v40
    v_exp_f32 v82, v82
    v_exp_f32 v83, v83
    v_exp_f32 v84, v84
    v_exp_f32 v85, v85
    s_waitcnt lgkmcnt(2)
    v_mfma_f32_32x32x16_bf16 v[64:79], v[16:19], v[12:15], 0
    ds_read_b128 v[20:23], v41 offset:41984
    s_setprio 0
    v_exp_f32 v86, v86
    s_add_u32 s76, s72, 270336
    s_add_u32 m0, s73, 33792
    s_nop 0
    buffer_load_dwordx4 v8, s[16:19], s76 offen lds
    s_mov_b64 exec, s[40:41]
    ds_read_b128 v[24:27], v3 offset:40960
    ds_read_b128 v[28:31], v3 offset:41472
    s_mov_b64 exec, -1
    v_exp_f32 v87, v87
    v_exp_f32 v88, v88
    v_exp_f32 v89, v89
    v_exp_f32 v90, v90
    v_exp_f32 v91, v91
    v_exp_f32 v92, v92
    v_exp_f32 v93, v93
    v_exp_f32 v94, v94
    v_exp_f32 v95, v95
    s_waitcnt lgkmcnt(3)
    v_smfmac_f32_32x32x32_bf16 v[48:63], v[32:35], v[80:87], v40
    s_barrier
    v_exp_f32 v64, v64
    v_exp_f32 v65, v65
    v_smfmac_f32_32x32x32_bf16 v[48:63], v[36:39], v[88:95], v40
    v_exp_f32 v66, v66
    v_exp_f32 v67, v67
    v_exp_f32 v68, v68
    v_exp_f32 v69, v69
    s_waitcnt lgkmcnt(2)
    v_mfma_f32_32x32x16_bf16 v[80:95], v[20:23], v[12:15], 0
    ds_read_b128 v[16:19], v41 offset:43008
    s_setprio 3
    v_exp_f32 v70, v70
    buffer_load_dwordx4 a[40:43], v1, s[24:27], s74 offen offset:0 sc1
    s_mov_b64 exec, s[40:41]
    ds_read_b128 v[32:35], v3 offset:41984
    ds_read_b128 v[36:39], v3 offset:42496
    s_mov_b64 exec, -1
    v_exp_f32 v71, v71
    v_exp_f32 v72, v72
    v_exp_f32 v73, v73
    v_exp_f32 v74, v74
    v_exp_f32 v75, v75
    v_exp_f32 v76, v76
    v_exp_f32 v77, v77
    v_exp_f32 v78, v78
    v_exp_f32 v79, v79
    s_waitcnt lgkmcnt(3)
    v_smfmac_f32_32x32x32_bf16 v[48:63], v[24:27], v[64:71], v40
    v_exp_f32 v80, v80
    v_exp_f32 v81, v81
    v_smfmac_f32_32x32x32_bf16 v[48:63], v[28:31], v[72:79], v40
    v_exp_f32 v82, v82
    v_exp_f32 v83, v83
    v_exp_f32 v84, v84
    v_exp_f32 v85, v85
    s_waitcnt lgkmcnt(2)
    v_mfma_f32_32x32x16_bf16 v[64:79], v[16:19], v[12:15], 0
    ds_read_b128 v[20:23], v41 offset:44032
    s_setprio 2
    v_exp_f32 v86, v86
    buffer_load_dwordx4 a[44:47], v1, s[24:27], s74 offen offset:1024 sc1
    s_add_u32 s74, s74, 8192
    s_mov_b64 exec, s[40:41]
    ds_read_b128 v[24:27], v3 offset:43008
    ds_read_b128 v[28:31], v3 offset:43520
    s_mov_b64 exec, -1
    v_exp_f32 v87, v87
    v_exp_f32 v88, v88
    v_exp_f32 v89, v89
    v_exp_f32 v90, v90
    v_exp_f32 v91, v91
    v_exp_f32 v92, v92
    v_exp_f32 v93, v93
    v_exp_f32 v94, v94
    v_exp_f32 v95, v95
    s_waitcnt lgkmcnt(3)
    v_smfmac_f32_32x32x32_bf16 v[48:63], v[32:35], v[80:87], v40
    v_exp_f32 v64, v64
    v_exp_f32 v65, v65
    v_smfmac_f32_32x32x32_bf16 v[48:63], v[36:39], v[88:95], v40
    v_exp_f32 v66, v66
    v_exp_f32 v67, v67
    v_exp_f32 v68, v68
    v_exp_f32 v69, v69
    s_waitcnt lgkmcnt(2)
    v_mfma_f32_32x32x16_bf16 v[80:95], v[20:23], v[12:15], 0
    ds_read_b128 v[16:19], v41 offset:49152
    s_setprio 1
    v_exp_f32 v70, v70
    s_add_u32 s76, s72, 393216
    s_add_u32 m0, s73, 49152
    s_nop 0
    buffer_load_dwordx4 v8, s[16:19], s76 offen lds
    s_mov_b64 exec, s[40:41]
    ds_read_b128 v[32:35], v3 offset:44032
    ds_read_b128 v[36:39], v3 offset:44544
    s_mov_b64 exec, -1
    v_exp_f32 v71, v71
    v_exp_f32 v72, v72
    v_exp_f32 v73, v73
    v_exp_f32 v74, v74
    v_exp_f32 v75, v75
    v_exp_f32 v76, v76
    v_exp_f32 v77, v77
    v_exp_f32 v78, v78
    v_exp_f32 v79, v79
    s_waitcnt lgkmcnt(3)
    v_smfmac_f32_32x32x32_bf16 v[48:63], v[24:27], v[64:71], v40
    v_exp_f32 v80, v80
    v_exp_f32 v81, v81
    v_smfmac_f32_32x32x32_bf16 v[48:63], v[28:31], v[72:79], v40
    v_exp_f32 v82, v82
    v_exp_f32 v83, v83
    v_exp_f32 v84, v84
    v_exp_f32 v85, v85
    s_waitcnt lgkmcnt(2)
    v_mfma_f32_32x32x16_bf16 v[64:79], v[16:19], v[12:15], 0
    ds_read_b128 v[20:23], v41 offset:50176
    s_setprio 0
    v_exp_f32 v86, v86
    s_add_u32 s76, s72, 401408
    s_add_u32 m0, s73, 50176
    s_nop 0
    buffer_load_dwordx4 v8, s[16:19], s76 offen lds
    s_mov_b64 exec, s[40:41]
    ds_read_b128 v[24:27], v3 offset:49152
    ds_read_b128 v[28:31], v3 offset:49664
    s_mov_b64 exec, -1
    v_exp_f32 v87, v87
    v_exp_f32 v88, v88
    v_exp_f32 v89, v89
    v_exp_f32 v90, v90
    v_exp_f32 v91, v91
    v_exp_f32 v92, v92
    v_exp_f32 v93, v93
    v_exp_f32 v94, v94
    v_exp_f32 v95, v95
    s_waitcnt lgkmcnt(3)
    v_smfmac_f32_32x32x32_bf16 v[48:63], v[32:35], v[80:87], v40
    s_waitcnt vmcnt(6)
    s_barrier
    v_add_u32 v6, 0, v4
    v_add_u32 v7, 0, v5
    v_exp_f32 v64, v64
    v_exp_f32 v65, v65
    v_smfmac_f32_32x32x32_bf16 v[48:63], v[36:39], v[88:95], v40
    v_exp_f32 v66, v66
    v_exp_f32 v67, v67
    v_exp_f32 v68, v68
    v_exp_f32 v69, v69
    s_waitcnt lgkmcnt(2)
    v_mfma_f32_32x32x16_bf16 v[80:95], v[20:23], v[12:15], 0
    ds_read_b128 v[16:19], v41 offset:51200
    s_setprio 3
    ds_read_b64_tr_b16 v[96:97], v6 offset:0
    ds_read_b64_tr_b16 v[98:99], v6 offset:1024
    v_exp_f32 v70, v70
    buffer_load_dwordx4 a[48:51], v1, s[24:27], s74 offen offset:0 sc1
    s_mov_b64 exec, s[40:41]
    ds_read_b128 v[32:35], v3 offset:50176
    ds_read_b128 v[36:39], v3 offset:50688
    s_mov_b64 exec, -1
    v_exp_f32 v71, v71
    v_exp_f32 v72, v72
    v_exp_f32 v73, v73
    v_exp_f32 v74, v74
    s_waitcnt lgkmcnt(2)
    v_mfma_f32_32x32x16_bf16 a[0:15], v[96:99], a[32:35], 0
    v_exp_f32 v75, v75
    v_exp_f32 v76, v76
    v_exp_f32 v77, v77
    v_exp_f32 v78, v78
    v_exp_f32 v79, v79
    v_smfmac_f32_32x32x32_bf16 v[48:63], v[24:27], v[64:71], v40
    v_exp_f32 v80, v80
    v_exp_f32 v81, v81
    v_smfmac_f32_32x32x32_bf16 v[48:63], v[28:31], v[72:79], v40
    v_exp_f32 v82, v82
    v_exp_f32 v83, v83
    v_exp_f32 v84, v84
    v_exp_f32 v85, v85
    v_mfma_f32_32x32x16_bf16 v[64:79], v[16:19], v[12:15], 0
    ds_read_b128 v[20:23], v41 offset:52224
    s_setprio 2
    ds_read_b64_tr_b16 v[100:101], v7 offset:0
    ds_read_b64_tr_b16 v[102:103], v7 offset:1024
    v_exp_f32 v86, v86
    buffer_load_dwordx4 a[52:55], v1, s[24:27], s74 offen offset:1024 sc1
    s_add_u32 s74, s74, 8192
    s_mov_b64 exec, s[40:41]
    ds_read_b128 v[24:27], v3 offset:51200
    ds_read_b128 v[28:31], v3 offset:51712
    s_mov_b64 exec, -1
    v_exp_f32 v87, v87
    v_exp_f32 v88, v88
    v_exp_f32 v89, v89
    v_exp_f32 v90, v90
    s_waitcnt lgkmcnt(2)
    v_mfma_f32_32x32x16_bf16 a[16:31], v[100:103], a[32:35], 0
    v_exp_f32 v91, v91
    v_exp_f32 v92, v92
    v_exp_f32 v93, v93
    v_exp_f32 v94, v94
    v_exp_f32 v95, v95
    v_smfmac_f32_32x32x32_bf16 v[48:63], v[32:35], v[80:87], v40
    v_exp_f32 v64, v64
    v_exp_f32 v65, v65
    v_smfmac_f32_32x32x32_bf16 v[48:63], v[36:39], v[88:95], v40
    v_exp_f32 v66, v66
    v_exp_f32 v67, v67
    v_exp_f32 v68, v68
    v_exp_f32 v69, v69
    v_mfma_f32_32x32x16_bf16 v[80:95], v[20:23], v[12:15], 0
    ds_read_b128 v[16:19], v41 offset:57344
    s_setprio 1
    ds_read_b64_tr_b16 v[104:105], v6 offset:2048
    ds_read_b64_tr_b16 v[106:107], v6 offset:3072
    v_exp_f32 v70, v70
    v_and_b32 v9, 31, v0
    v_lshlrev_b32 v9, 2, v9
    s_lshl_b32 s76, s45, 3
    s_add_u32 s76, s76, s3
    s_lshl_b32 s76, s76, 7
    s_add_u32 s76, s76, 14680064
    buffer_load_dword v10, v9, s[24:27], s76 offen sc1
    s_mov_b64 exec, s[40:41]
    ds_read_b128 v[32:35], v3 offset:52224
    ds_read_b128 v[36:39], v3 offset:52736
    s_mov_b64 exec, -1
    v_exp_f32 v71, v71
    v_exp_f32 v72, v72
    v_exp_f32 v73, v73
    v_exp_f32 v74, v74
    s_waitcnt lgkmcnt(2)
    v_mfma_f32_32x32x16_bf16 a[0:15], v[104:107], a[36:39], a[0:15]
    v_exp_f32 v75, v75
    v_exp_f32 v76, v76
    v_exp_f32 v77, v77
    v_exp_f32 v78, v78
    v_exp_f32 v79, v79
    v_smfmac_f32_32x32x32_bf16 v[48:63], v[24:27], v[64:71], v40
    v_exp_f32 v80, v80
    v_exp_f32 v81, v81
    v_smfmac_f32_32x32x32_bf16 v[48:63], v[28:31], v[72:79], v40
    v_exp_f32 v82, v82
    v_exp_f32 v83, v83
    v_exp_f32 v84, v84
    v_exp_f32 v85, v85
    v_mfma_f32_32x32x16_bf16 v[64:79], v[16:19], v[12:15], 0
    ds_read_b128 v[20:23], v41 offset:58368
    s_setprio 0
    ds_read_b64_tr_b16 v[108:109], v7 offset:2048
    ds_read_b64_tr_b16 v[110:111], v7 offset:3072
    v_exp_f32 v86, v86
    s_lshl_b32 s76, s46, 1
    s_and_b32 s77, s3, 1
    s_add_u32 s76, s76, s77
    s_lshl_b32 s76, s76, 7
    s_add_u32 s76, s76, 14680064
    buffer_load_dword v11, v9, s[24:27], s76 offen sc1
    s_mov_b64 exec, s[40:41]
    ds_read_b128 v[24:27], v3 offset:57344
    ds_read_b128 v[28:31], v3 offset:57856
    s_mov_b64 exec, -1
    v_exp_f32 v87, v87
    v_exp_f32 v88, v88
    v_exp_f32 v89, v89
    v_exp_f32 v90, v90
    s_waitcnt lgkmcnt(2)
    v_mfma_f32_32x32x16_bf16 a[16:31], v[108:111], a[36:39], a[16:31]
    v_exp_f32 v91, v91
    v_exp_f32 v92, v92
    v_exp_f32 v93, v93
    v_exp_f32 v94, v94
    v_exp_f32 v95, v95
    v_smfmac_f32_32x32x32_bf16 v[48:63], v[32:35], v[80:87], v40
    s_waitcnt vmcnt(6)
    s_barrier
    v_add_u32 v6, 16384, v4
    v_add_u32 v7, 16384, v5
    v_exp_f32 v64, v64
    v_exp_f32 v65, v65
    v_smfmac_f32_32x32x32_bf16 v[48:63], v[36:39], v[88:95], v40
    v_exp_f32 v66, v66
    v_exp_f32 v67, v67
    v_exp_f32 v68, v68
    v_exp_f32 v69, v69
    v_mfma_f32_32x32x16_bf16 v[80:95], v[20:23], v[12:15], 0
    ds_read_b128 v[16:19], v41 offset:59392
    s_setprio 3
    ds_read_b64_tr_b16 v[96:97], v6 offset:0
    ds_read_b64_tr_b16 v[98:99], v6 offset:1024
    v_exp_f32 v70, v70
    buffer_load_dwordx4 a[56:59], v1, s[24:27], s74 offen offset:0 sc1
    buffer_load_dwordx4 a[60:63], v1, s[24:27], s74 offen offset:1024 sc1
    s_add_u32 s74, s74, 8192
    s_mov_b64 exec, s[40:41]
    ds_read_b128 v[32:35], v3 offset:58368
    ds_read_b128 v[36:39], v3 offset:58880
    s_mov_b64 exec, -1
    v_exp_f32 v71, v71
    v_exp_f32 v72, v72
    v_exp_f32 v73, v73
    v_exp_f32 v74, v74
    s_waitcnt lgkmcnt(2)
    v_mfma_f32_32x32x16_bf16 a[0:15], v[96:99], a[40:43], a[0:15]
    v_exp_f32 v75, v75
    v_exp_f32 v76, v76
    v_exp_f32 v77, v77
    v_exp_f32 v78, v78
    v_exp_f32 v79, v79
    v_smfmac_f32_32x32x32_bf16 v[48:63], v[24:27], v[64:71], v40
    v_exp_f32 v80, v80
    v_exp_f32 v81, v81
    v_smfmac_f32_32x32x32_bf16 v[48:63], v[28:31], v[72:79], v40
    v_exp_f32 v82, v82
    v_exp_f32 v83, v83
    v_exp_f32 v84, v84
    v_exp_f32 v85, v85
    v_mfma_f32_32x32x16_bf16 v[64:79], v[16:19], v[12:15], 0
    ds_read_b128 v[20:23], v41 offset:60416
    s_setprio 2
    ds_read_b64_tr_b16 v[100:101], v7 offset:0
    ds_read_b64_tr_b16 v[102:103], v7 offset:1024
    v_exp_f32 v86, v86
    s_add_u32 s76, s72, 524288
    s_add_u32 m0, s73, 0
    s_nop 0
    buffer_load_dwordx4 v8, s[16:19], s76 offen lds
    s_add_u32 s76, s72, 532480
    s_add_u32 m0, s73, 1024
    s_nop 0
    buffer_load_dwordx4 v8, s[16:19], s76 offen lds
    s_mov_b64 exec, s[40:41]
    ds_read_b128 v[24:27], v3 offset:59392
    ds_read_b128 v[28:31], v3 offset:59904
    s_mov_b64 exec, -1
    v_exp_f32 v87, v87
    v_exp_f32 v88, v88
    v_exp_f32 v89, v89
    v_exp_f32 v90, v90
    s_waitcnt lgkmcnt(2)
    v_mfma_f32_32x32x16_bf16 a[16:31], v[100:103], a[40:43], a[16:31]
    v_exp_f32 v91, v91
    v_exp_f32 v92, v92
    v_exp_f32 v93, v93
    v_exp_f32 v94, v94
    v_exp_f32 v95, v95
    v_smfmac_f32_32x32x32_bf16 v[48:63], v[32:35], v[80:87], v40
    v_exp_f32 v64, v64
    v_exp_f32 v65, v65
    v_smfmac_f32_32x32x32_bf16 v[48:63], v[36:39], v[88:95], v40
    v_exp_f32 v66, v66
    v_exp_f32 v67, v67
    v_exp_f32 v68, v68
    v_exp_f32 v69, v69
    v_mfma_f32_32x32x16_bf16 v[80:95], v[20:23], v[12:15], 0
    ds_read_b128 v[16:19], v42 offset:0
    s_setprio 1
    ds_read_b64_tr_b16 v[104:105], v6 offset:2048
    ds_read_b64_tr_b16 v[106:107], v6 offset:3072
    v_exp_f32 v70, v70
    s_add_u32 s76, s72, 0
    s_add_u32 m0, s73, 65536
    s_nop 0
    buffer_load_dwordx4 v8, s[20:23], s76 offen lds
    s_mov_b64 exec, s[40:41]
    ds_read_b128 v[32:35], v3 offset:60416
    ds_read_b128 v[36:39], v3 offset:60928
    s_mov_b64 exec, -1
    v_exp_f32 v71, v71
    v_exp_f32 v72, v72
    v_exp_f32 v73, v73
    v_exp_f32 v74, v74
    s_waitcnt lgkmcnt(2)
    v_mfma_f32_32x32x16_bf16 a[0:15], v[104:107], a[44:47], a[0:15]
    v_exp_f32 v75, v75
    v_exp_f32 v76, v76
    v_exp_f32 v77, v77
    v_exp_f32 v78, v78
    v_exp_f32 v79, v79
    v_smfmac_f32_32x32x32_bf16 v[48:63], v[24:27], v[64:71], v40
    v_exp_f32 v80, v80
    v_exp_f32 v81, v81
    v_smfmac_f32_32x32x32_bf16 v[48:63], v[28:31], v[72:79], v40
    v_exp_f32 v82, v82
    v_exp_f32 v83, v83
    v_exp_f32 v84, v84
    v_exp_f32 v85, v85
    v_mfma_f32_32x32x16_bf16 v[64:79], v[16:19], v[12:15], 0
    ds_read_b128 v[20:23], v42 offset:1024
    s_setprio 0
    ds_read_b64_tr_b16 v[108:109], v7 offset:2048
    ds_read_b64_tr_b16 v[110:111], v7 offset:3072
    v_exp_f32 v86, v86
    s_add_u32 s76, s72, 8192
    s_add_u32 m0, s73, 66560
    s_nop 0
    buffer_load_dwordx4 v8, s[20:23], s76 offen lds
    s_mov_b64 exec, s[40:41]
    ds_read_b128 v[24:27], v43 offset:0
    ds_read_b128 v[28:31], v43 offset:512
    s_mov_b64 exec, -1
    v_exp_f32 v87, v87
    v_exp_f32 v88, v88
    v_exp_f32 v89, v89
    v_exp_f32 v90, v90
    s_waitcnt lgkmcnt(2)
    v_mfma_f32_32x32x16_bf16 a[16:31], v[108:111], a[44:47], a[16:31]
    v_exp_f32 v91, v91
    v_exp_f32 v92, v92
    v_exp_f32 v93, v93
    v_exp_f32 v94, v94
    v_exp_f32 v95, v95
    v_smfmac_f32_32x32x32_bf16 v[48:63], v[32:35], v[80:87], v40
    s_waitcnt vmcnt(8)
    s_barrier
    v_add_u32 v6, 32768, v4
    v_add_u32 v7, 32768, v5
    v_exp_f32 v64, v64
    v_exp_f32 v65, v65
    v_smfmac_f32_32x32x32_bf16 v[48:63], v[36:39], v[88:95], v40
    v_exp_f32 v66, v66
    v_exp_f32 v67, v67
    v_exp_f32 v68, v68
    v_exp_f32 v69, v69
    v_mfma_f32_32x32x16_bf16 v[80:95], v[20:23], v[12:15], 0
    ds_read_b128 v[16:19], v42 offset:2048
    s_setprio 3
    ds_read_b64_tr_b16 v[96:97], v6 offset:0
    ds_read_b64_tr_b16 v[98:99], v6 offset:1024
    v_exp_f32 v70, v70
    buffer_load_dwordx4 a[64:67], v1, s[24:27], s74 offen offset:0 sc1
    s_mov_b64 exec, s[40:41]
    ds_read_b128 v[32:35], v43 offset:1024
    ds_read_b128 v[36:39], v43 offset:1536
    s_mov_b64 exec, -1
    v_exp_f32 v71, v71
    v_exp_f32 v72, v72
    v_exp_f32 v73, v73
    v_exp_f32 v74, v74
    s_waitcnt lgkmcnt(2)
    v_mfma_f32_32x32x16_bf16 a[0:15], v[96:99], a[48:51], a[0:15]
    v_exp_f32 v75, v75
    v_exp_f32 v76, v76
    v_exp_f32 v77, v77
    v_exp_f32 v78, v78
    v_exp_f32 v79, v79
    v_smfmac_f32_32x32x32_bf16 v[48:63], v[24:27], v[64:71], v40
    v_exp_f32 v80, v80
    v_exp_f32 v81, v81
    v_smfmac_f32_32x32x32_bf16 v[48:63], v[28:31], v[72:79], v40
    v_exp_f32 v82, v82
    v_exp_f32 v83, v83
    v_exp_f32 v84, v84
    v_exp_f32 v85, v85
    v_mfma_f32_32x32x16_bf16 v[64:79], v[16:19], v[12:15], 0
    ds_read_b128 v[20:23], v42 offset:3072
    s_setprio 2
    ds_read_b64_tr_b16 v[100:101], v7 offset:0
    ds_read_b64_tr_b16 v[102:103], v7 offset:1024
    v_exp_f32 v86, v86
    buffer_load_dwordx4 a[68:71], v1, s[24:27], s74 offen offset:1024 sc1
    s_add_u32 s74, s74, 8192
    s_mov_b64 exec, s[40:41]
    ds_read_b128 v[24:27], v43 offset:2048
    ds_read_b128 v[28:31], v43 offset:2560
    s_mov_b64 exec, -1
    v_exp_f32 v87, v87
    v_exp_f32 v88, v88
    v_exp_f32 v89, v89
    v_exp_f32 v90, v90
    s_waitcnt lgkmcnt(2)
    v_mfma_f32_32x32x16_bf16 a[16:31], v[100:103], a[48:51], a[16:31]
    v_exp_f32 v91, v91
    v_exp_f32 v92, v92
    v_exp_f32 v93, v93
    v_exp_f32 v94, v94
    v_exp_f32 v95, v95
    v_smfmac_f32_32x32x32_bf16 v[48:63], v[32:35], v[80:87], v40
    v_exp_f32 v64, v64
    v_exp_f32 v65, v65
    v_smfmac_f32_32x32x32_bf16 v[48:63], v[36:39], v[88:95], v40
    v_exp_f32 v66, v66
    v_exp_f32 v67, v67
    v_exp_f32 v68, v68
    v_exp_f32 v69, v69
    v_mfma_f32_32x32x16_bf16 v[80:95], v[20:23], v[12:15], 0
    ds_read_b128 v[16:19], v42 offset:8192
    s_setprio 1
    ds_read_b64_tr_b16 v[104:105], v6 offset:2048
    ds_read_b64_tr_b16 v[106:107], v6 offset:3072
    v_exp_f32 v70, v70
    s_add_u32 s76, s72, 655360
    s_add_u32 m0, s73, 16384
    s_nop 0
    buffer_load_dwordx4 v8, s[16:19], s76 offen lds
    s_mov_b64 exec, s[40:41]
    ds_read_b128 v[32:35], v43 offset:3072
    ds_read_b128 v[36:39], v43 offset:3584
    s_mov_b64 exec, -1
    v_exp_f32 v71, v71
    v_exp_f32 v72, v72
    v_exp_f32 v73, v73
    v_exp_f32 v74, v74
    s_waitcnt lgkmcnt(2)
    v_mfma_f32_32x32x16_bf16 a[0:15], v[104:107], a[52:55], a[0:15]
    v_exp_f32 v75, v75
    v_exp_f32 v76, v76
    v_exp_f32 v77, v77
    v_exp_f32 v78, v78
    v_exp_f32 v79, v79
    v_smfmac_f32_32x32x32_bf16 v[48:63], v[24:27], v[64:71], v40
    v_exp_f32 v80, v80
    v_exp_f32 v81, v81
    v_smfmac_f32_32x32x32_bf16 v[48:63], v[28:31], v[72:79], v40
    v_exp_f32 v82, v82
    v_exp_f32 v83, v83
    v_exp_f32 v84, v84
    v_exp_f32 v85, v85
    v_mfma_f32_32x32x16_bf16 v[64:79], v[16:19], v[12:15], 0
    ds_read_b128 v[20:23], v42 offset:9216
    s_setprio 0
    ds_read_b64_tr_b16 v[108:109], v7 offset:2048
    ds_read_b64_tr_b16 v[110:111], v7 offset:3072
    v_exp_f32 v86, v86
    s_add_u32 s76, s72, 663552
    s_add_u32 m0, s73, 17408
    s_nop 0
    buffer_load_dwordx4 v8, s[16:19], s76 offen lds
    s_mov_b64 exec, s[40:41]
    ds_read_b128 v[24:27], v43 offset:8192
    ds_read_b128 v[28:31], v43 offset:8704
    s_mov_b64 exec, -1
    v_exp_f32 v87, v87
    v_exp_f32 v88, v88
    v_exp_f32 v89, v89
    v_exp_f32 v90, v90
    s_waitcnt lgkmcnt(2)
    v_mfma_f32_32x32x16_bf16 a[16:31], v[108:111], a[52:55], a[16:31]
    v_exp_f32 v91, v91
    v_exp_f32 v92, v92
    v_exp_f32 v93, v93
    v_exp_f32 v94, v94
    v_exp_f32 v95, v95
    v_smfmac_f32_32x32x32_bf16 v[48:63], v[32:35], v[80:87], v40
    s_waitcnt vmcnt(8)
    s_barrier
    v_add_u32 v6, 49152, v4
    v_add_u32 v7, 49152, v5
    v_exp_f32 v64, v64
    v_exp_f32 v65, v65
    v_smfmac_f32_32x32x32_bf16 v[48:63], v[36:39], v[88:95], v40
    v_exp_f32 v66, v66
    v_exp_f32 v67, v67
    v_exp_f32 v68, v68
    v_exp_f32 v69, v69
    v_mfma_f32_32x32x16_bf16 v[80:95], v[20:23], v[12:15], 0
    ds_read_b128 v[16:19], v42 offset:10240
    s_setprio 3
    ds_read_b64_tr_b16 v[96:97], v6 offset:0
    ds_read_b64_tr_b16 v[98:99], v6 offset:1024
    v_exp_f32 v70, v70
    buffer_load_dwordx4 a[72:75], v1, s[24:27], s74 offen offset:0 sc1
    buffer_load_dwordx4 a[76:79], v1, s[24:27], s74 offen offset:1024 sc1
    s_add_u32 s74, s74, 8192
    s_mov_b64 exec, s[40:41]
    ds_read_b128 v[32:35], v43 offset:9216
    ds_read_b128 v[36:39], v43 offset:9728
    s_mov_b64 exec, -1
    v_exp_f32 v71, v71
    v_exp_f32 v72, v72
    v_exp_f32 v73, v73
    v_exp_f32 v74, v74
    s_waitcnt lgkmcnt(2)
    v_mfma_f32_32x32x16_bf16 a[0:15], v[96:99], a[56:59], a[0:15]
    v_exp_f32 v75, v75
    v_exp_f32 v76, v76
    v_exp_f32 v77, v77
    v_exp_f32 v78, v78
    v_exp_f32 v79, v79
    v_smfmac_f32_32x32x32_bf16 v[48:63], v[24:27], v[64:71], v40
    v_exp_f32 v80, v80
    v_exp_f32 v81, v81
    v_smfmac_f32_32x32x32_bf16 v[48:63], v[28:31], v[72:79], v40
    v_exp_f32 v82, v82
    v_exp_f32 v83, v83
    v_exp_f32 v84, v84
    v_exp_f32 v85, v85
    v_mfma_f32_32x32x16_bf16 v[64:79], v[16:19], v[12:15], 0
    ds_read_b128 v[20:23], v42 offset:11264
    s_setprio 2
    ds_read_b64_tr_b16 v[100:101], v7 offset:0
    ds_read_b64_tr_b16 v[102:103], v7 offset:1024
    v_exp_f32 v86, v86
    s_add_u32 s76, s72, 786432
    s_add_u32 m0, s73, 32768
    s_nop 0
    buffer_load_dwordx4 v8, s[16:19], s76 offen lds
    s_add_u32 s76, s72, 794624
    s_add_u32 m0, s73, 33792
    s_nop 0
    buffer_load_dwordx4 v8, s[16:19], s76 offen lds
    s_mov_b64 exec, s[40:41]
    ds_read_b128 v[24:27], v43 offset:10240
    ds_read_b128 v[28:31], v43 offset:10752
    s_mov_b64 exec, -1
    v_exp_f32 v87, v87
    v_exp_f32 v88, v88
    v_exp_f32 v89, v89
    v_exp_f32 v90, v90
    s_waitcnt lgkmcnt(2)
    v_mfma_f32_32x32x16_bf16 a[16:31], v[100:103], a[56:59], a[16:31]
    v_exp_f32 v91, v91
    v_exp_f32 v92, v92
    v_exp_f32 v93, v93
    v_exp_f32 v94, v94
    v_exp_f32 v95, v95
    v_smfmac_f32_32x32x32_bf16 v[48:63], v[32:35], v[80:87], v40
    v_exp_f32 v64, v64
    v_exp_f32 v65, v65
    v_smfmac_f32_32x32x32_bf16 v[48:63], v[36:39], v[88:95], v40
    v_exp_f32 v66, v66
    v_exp_f32 v67, v67
    v_exp_f32 v68, v68
    v_exp_f32 v69, v69
    v_mfma_f32_32x32x16_bf16 v[80:95], v[20:23], v[12:15], 0
    ds_read_b128 v[16:19], v42 offset:16384
    s_setprio 1
    ds_read_b64_tr_b16 v[104:105], v6 offset:2048
    ds_read_b64_tr_b16 v[106:107], v6 offset:3072
    v_exp_f32 v70, v70
    s_add_u32 s76, s72, 131072
    s_add_u32 m0, s73, 81920
    s_nop 0
    buffer_load_dwordx4 v8, s[20:23], s76 offen lds
    s_mov_b64 exec, s[40:41]
    ds_read_b128 v[32:35], v43 offset:11264
    ds_read_b128 v[36:39], v43 offset:11776
    s_mov_b64 exec, -1
    v_exp_f32 v71, v71
    v_exp_f32 v72, v72
    v_exp_f32 v73, v73
    v_exp_f32 v74, v74
    s_waitcnt lgkmcnt(2)
    v_mfma_f32_32x32x16_bf16 a[0:15], v[104:107], a[60:63], a[0:15]
    v_exp_f32 v75, v75
    v_exp_f32 v76, v76
    v_exp_f32 v77, v77
    v_exp_f32 v78, v78
    v_exp_f32 v79, v79
    v_smfmac_f32_32x32x32_bf16 v[48:63], v[24:27], v[64:71], v40
    v_exp_f32 v80, v80
    v_exp_f32 v81, v81
    v_smfmac_f32_32x32x32_bf16 v[48:63], v[28:31], v[72:79], v40
    v_exp_f32 v82, v82
    v_exp_f32 v83, v83
    v_exp_f32 v84, v84
    v_exp_f32 v85, v85
    v_mfma_f32_32x32x16_bf16 v[64:79], v[16:19], v[12:15], 0
    ds_read_b128 v[20:23], v42 offset:17408
    s_setprio 0
    ds_read_b64_tr_b16 v[108:109], v7 offset:2048
    ds_read_b64_tr_b16 v[110:111], v7 offset:3072
    v_exp_f32 v86, v86
    s_add_u32 s76, s72, 139264
    s_add_u32 m0, s73, 82944
    s_nop 0
    buffer_load_dwordx4 v8, s[20:23], s76 offen lds
    s_mov_b64 exec, s[40:41]
    ds_read_b128 v[24:27], v43 offset:16384
    ds_read_b128 v[28:31], v43 offset:16896
    s_mov_b64 exec, -1
    v_exp_f32 v87, v87
    v_exp_f32 v88, v88
    v_exp_f32 v89, v89
    v_exp_f32 v90, v90
    s_waitcnt lgkmcnt(2)
    v_mfma_f32_32x32x16_bf16 a[16:31], v[108:111], a[60:63], a[16:31]
    v_exp_f32 v91, v91
    v_exp_f32 v92, v92
    v_exp_f32 v93, v93
    v_exp_f32 v94, v94
    v_exp_f32 v95, v95
    v_smfmac_f32_32x32x32_bf16 v[48:63], v[32:35], v[80:87], v40
    s_waitcnt vmcnt(8)
    s_barrier
    v_add_u32 v6, 0, v4
    v_add_u32 v7, 0, v5
    v_exp_f32 v64, v64
    v_exp_f32 v65, v65
    v_smfmac_f32_32x32x32_bf16 v[48:63], v[36:39], v[88:95], v40
    v_exp_f32 v66, v66
    v_exp_f32 v67, v67
    v_exp_f32 v68, v68
    v_exp_f32 v69, v69
    v_mfma_f32_32x32x16_bf16 v[80:95], v[20:23], v[12:15], 0
    ds_read_b128 v[16:19], v42 offset:18432
    s_setprio 3
    ds_read_b64_tr_b16 v[96:97], v6 offset:0
    ds_read_b64_tr_b16 v[98:99], v6 offset:1024
    v_exp_f32 v70, v70
    buffer_load_dwordx4 a[80:83], v1, s[24:27], s74 offen offset:0 sc1
    s_mov_b64 exec, s[40:41]
    ds_read_b128 v[32:35], v43 offset:17408
    ds_read_b128 v[36:39], v43 offset:17920
    s_mov_b64 exec, -1
    v_exp_f32 v71, v71
    v_exp_f32 v72, v72
    v_exp_f32 v73, v73
    v_exp_f32 v74, v74
    s_waitcnt lgkmcnt(2)
    v_mfma_f32_32x32x16_bf16 a[0:15], v[96:99], a[64:67], a[0:15]
    v_exp_f32 v75, v75
    v_exp_f32 v76, v76
    v_exp_f32 v77, v77
    v_exp_f32 v78, v78
    v_exp_f32 v79, v79
    v_smfmac_f32_32x32x32_bf16 v[48:63], v[24:27], v[64:71], v40
    v_exp_f32 v80, v80
    v_exp_f32 v81, v81
    v_smfmac_f32_32x32x32_bf16 v[48:63], v[28:31], v[72:79], v40
    v_exp_f32 v82, v82
    v_exp_f32 v83, v83
    v_exp_f32 v84, v84
    v_exp_f32 v85, v85
    v_mfma_f32_32x32x16_bf16 v[64:79], v[16:19], v[12:15], 0
    ds_read_b128 v[20:23], v42 offset:19456
    s_setprio 2
    ds_read_b64_tr_b16 v[100:101], v7 offset:0
    ds_read_b64_tr_b16 v[102:103], v7 offset:1024
    v_exp_f32 v86, v86
    buffer_load_dwordx4 a[84:87], v1, s[24:27], s74 offen offset:1024 sc1
    s_add_u32 s74, s74, 8192
    s_mov_b64 exec, s[40:41]
    ds_read_b128 v[24:27], v43 offset:18432
    ds_read_b128 v[28:31], v43 offset:18944
    s_mov_b64 exec, -1
    v_exp_f32 v87, v87
    v_exp_f32 v88, v88
    v_exp_f32 v89, v89
    v_exp_f32 v90, v90
    s_waitcnt lgkmcnt(2)
    v_mfma_f32_32x32x16_bf16 a[16:31], v[100:103], a[64:67], a[16:31]
    v_exp_f32 v91, v91
    v_exp_f32 v92, v92
    v_exp_f32 v93, v93
    v_exp_f32 v94, v94
    v_exp_f32 v95, v95
    v_smfmac_f32_32x32x32_bf16 v[48:63], v[32:35], v[80:87], v40
    v_exp_f32 v64, v64
    v_exp_f32 v65, v65
    v_smfmac_f32_32x32x32_bf16 v[48:63], v[36:39], v[88:95], v40
    v_exp_f32 v66, v66
    v_exp_f32 v67, v67
    v_exp_f32 v68, v68
    v_exp_f32 v69, v69
    v_mfma_f32_32x32x16_bf16 v[80:95], v[20:23], v[12:15], 0
    ds_read_b128 v[16:19], v42 offset:24576
    s_setprio 1
    ds_read_b64_tr_b16 v[104:105], v6 offset:2048
    ds_read_b64_tr_b16 v[106:107], v6 offset:3072
    v_exp_f32 v70, v70
    s_add_u32 s76, s72, 917504
    s_add_u32 m0, s73, 49152
    s_nop 0
    buffer_load_dwordx4 v8, s[16:19], s76 offen lds
    s_mov_b64 exec, s[40:41]
    ds_read_b128 v[32:35], v43 offset:19456
    ds_read_b128 v[36:39], v43 offset:19968
    s_mov_b64 exec, -1
    v_exp_f32 v71, v71
    v_exp_f32 v72, v72
    v_exp_f32 v73, v73
    v_exp_f32 v74, v74
    s_waitcnt lgkmcnt(2)
    v_mfma_f32_32x32x16_bf16 a[0:15], v[104:107], a[68:71], a[0:15]
    v_exp_f32 v75, v75
    v_exp_f32 v76, v76
    v_exp_f32 v77, v77
    v_exp_f32 v78, v78
    v_exp_f32 v79, v79
    v_smfmac_f32_32x32x32_bf16 v[48:63], v[24:27], v[64:71], v40
    v_exp_f32 v80, v80
    v_exp_f32 v81, v81
    v_smfmac_f32_32x32x32_bf16 v[48:63], v[28:31], v[72:79], v40
    v_exp_f32 v82, v82
    v_exp_f32 v83, v83
    v_exp_f32 v84, v84
    v_exp_f32 v85, v85
    v_mfma_f32_32x32x16_bf16 v[64:79], v[16:19], v[12:15], 0
    ds_read_b128 v[20:23], v42 offset:25600
    s_setprio 0
    ds_read_b64_tr_b16 v[108:109], v7 offset:2048
    ds_read_b64_tr_b16 v[110:111], v7 offset:3072
    v_exp_f32 v86, v86
    s_add_u32 s76, s72, 925696
    s_add_u32 m0, s73, 50176
    s_nop 0
    buffer_load_dwordx4 v8, s[16:19], s76 offen lds
    s_mov_b64 exec, s[40:41]
    ds_read_b128 v[24:27], v43 offset:24576
    ds_read_b128 v[28:31], v43 offset:25088
    s_mov_b64 exec, -1
    v_exp_f32 v87, v87
    v_exp_f32 v88, v88
    v_exp_f32 v89, v89
    v_exp_f32 v90, v90
    s_waitcnt lgkmcnt(2)
    v_mfma_f32_32x32x16_bf16 a[16:31], v[108:111], a[68:71], a[16:31]
    v_exp_f32 v91, v91
    v_exp_f32 v92, v92
    v_exp_f32 v93, v93
    v_exp_f32 v94, v94
    v_exp_f32 v95, v95
    v_smfmac_f32_32x32x32_bf16 v[48:63], v[32:35], v[80:87], v40
    s_waitcnt vmcnt(8)
    s_barrier
    v_add_u32 v6, 16384, v4
    v_add_u32 v7, 16384, v5
    v_exp_f32 v64, v64
    v_exp_f32 v65, v65
    v_smfmac_f32_32x32x32_bf16 v[48:63], v[36:39], v[88:95], v40
    v_exp_f32 v66, v66
    v_exp_f32 v67, v67
    v_exp_f32 v68, v68
    v_exp_f32 v69, v69
    v_mfma_f32_32x32x16_bf16 v[80:95], v[20:23], v[12:15], 0
    ds_read_b128 v[16:19], v42 offset:26624
    s_setprio 3
    ds_read_b64_tr_b16 v[96:97], v6 offset:0
    ds_read_b64_tr_b16 v[98:99], v6 offset:1024
    v_exp_f32 v70, v70
    buffer_load_dwordx4 a[88:91], v1, s[24:27], s74 offen offset:0 sc1
    buffer_load_dwordx4 a[92:95], v1, s[24:27], s74 offen offset:1024 sc1
    s_add_u32 s74, s74, 8192
    s_mov_b64 exec, s[40:41]
    ds_read_b128 v[32:35], v43 offset:25600
    ds_read_b128 v[36:39], v43 offset:26112
    s_mov_b64 exec, -1
    v_exp_f32 v71, v71
    v_exp_f32 v72, v72
    v_exp_f32 v73, v73
    v_exp_f32 v74, v74
    s_waitcnt lgkmcnt(2)
    v_mfma_f32_32x32x16_bf16 a[0:15], v[96:99], a[72:75], a[0:15]
    v_exp_f32 v75, v75
    v_exp_f32 v76, v76
    v_exp_f32 v77, v77
    v_exp_f32 v78, v78
    v_exp_f32 v79, v79
    v_smfmac_f32_32x32x32_bf16 v[48:63], v[24:27], v[64:71], v40
    v_exp_f32 v80, v80
    v_exp_f32 v81, v81
    v_smfmac_f32_32x32x32_bf16 v[48:63], v[28:31], v[72:79], v40
    v_exp_f32 v82, v82
    v_exp_f32 v83, v83
    v_exp_f32 v84, v84
    v_exp_f32 v85, v85
    v_mfma_f32_32x32x16_bf16 v[64:79], v[16:19], v[12:15], 0
    ds_read_b128 v[20:23], v42 offset:27648
    s_setprio 2
    ds_read_b64_tr_b16 v[100:101], v7 offset:0
    ds_read_b64_tr_b16 v[102:103], v7 offset:1024
    v_exp_f32 v86, v86
    s_add_u32 s76, s72, 1048576
    s_add_u32 m0, s73, 0
    s_nop 0
    buffer_load_dwordx4 v8, s[16:19], s76 offen lds
    s_add_u32 s76, s72, 1056768
    s_add_u32 m0, s73, 1024
    s_nop 0
    buffer_load_dwordx4 v8, s[16:19], s76 offen lds
    s_mov_b64 exec, s[40:41]
    ds_read_b128 v[24:27], v43 offset:26624
    ds_read_b128 v[28:31], v43 offset:27136
    s_mov_b64 exec, -1
    v_exp_f32 v87, v87
    v_exp_f32 v88, v88
    v_exp_f32 v89, v89
    v_exp_f32 v90, v90
    s_waitcnt lgkmcnt(2)
    v_mfma_f32_32x32x16_bf16 a[16:31], v[100:103], a[72:75], a[16:31]
    v_exp_f32 v91, v91
    v_exp_f32 v92, v92
    v_exp_f32 v93, v93
    v_exp_f32 v94, v94
    v_exp_f32 v95, v95
    v_smfmac_f32_32x32x32_bf16 v[48:63], v[32:35], v[80:87], v40
    v_exp_f32 v64, v64
    v_exp_f32 v65, v65
    v_smfmac_f32_32x32x32_bf16 v[48:63], v[36:39], v[88:95], v40
    v_exp_f32 v66, v66
    v_exp_f32 v67, v67
    v_exp_f32 v68, v68
    v_exp_f32 v69, v69
    v_mfma_f32_32x32x16_bf16 v[80:95], v[20:23], v[12:15], 0
    ds_read_b128 v[16:19], v42 offset:32768
    s_setprio 1
    ds_read_b64_tr_b16 v[104:105], v6 offset:2048
    ds_read_b64_tr_b16 v[106:107], v6 offset:3072
    v_exp_f32 v70, v70
    s_add_u32 s76, s72, 262144
    s_add_u32 m0, s73, 98304
    s_nop 0
    buffer_load_dwordx4 v8, s[20:23], s76 offen lds
    s_mov_b64 exec, s[40:41]
    ds_read_b128 v[32:35], v43 offset:27648
    ds_read_b128 v[36:39], v43 offset:28160
    s_mov_b64 exec, -1
    v_exp_f32 v71, v71
    v_exp_f32 v72, v72
    v_exp_f32 v73, v73
    v_exp_f32 v74, v74
    s_waitcnt lgkmcnt(2)
    v_mfma_f32_32x32x16_bf16 a[0:15], v[104:107], a[76:79], a[0:15]
    v_exp_f32 v75, v75
    v_exp_f32 v76, v76
    v_exp_f32 v77, v77
    v_exp_f32 v78, v78
    v_exp_f32 v79, v79
    v_smfmac_f32_32x32x32_bf16 v[48:63], v[24:27], v[64:71], v40
    v_exp_f32 v80, v80
    v_exp_f32 v81, v81
    v_smfmac_f32_32x32x32_bf16 v[48:63], v[28:31], v[72:79], v40
    v_exp_f32 v82, v82
    v_exp_f32 v83, v83
    v_exp_f32 v84, v84
    v_exp_f32 v85, v85
    v_mfma_f32_32x32x16_bf16 v[64:79], v[16:19], v[12:15], 0
    ds_read_b128 v[20:23], v42 offset:33792
    s_setprio 0
    ds_read_b64_tr_b16 v[108:109], v7 offset:2048
    ds_read_b64_tr_b16 v[110:111], v7 offset:3072
    v_exp_f32 v86, v86
    s_add_u32 s76, s72, 270336
    s_add_u32 m0, s73, 99328
    s_nop 0
    buffer_load_dwordx4 v8, s[20:23], s76 offen lds
    s_mov_b64 exec, s[40:41]
    ds_read_b128 v[24:27], v43 offset:32768
    ds_read_b128 v[28:31], v43 offset:33280
    s_mov_b64 exec, -1
    v_exp_f32 v87, v87
    v_exp_f32 v88, v88
    v_exp_f32 v89, v89
    v_exp_f32 v90, v90
    s_waitcnt lgkmcnt(2)
    v_mfma_f32_32x32x16_bf16 a[16:31], v[108:111], a[76:79], a[16:31]
    v_exp_f32 v91, v91
    v_exp_f32 v92, v92
    v_exp_f32 v93, v93
    v_exp_f32 v94, v94
    v_exp_f32 v95, v95
    v_smfmac_f32_32x32x32_bf16 v[48:63], v[32:35], v[80:87], v40
    s_waitcnt vmcnt(8)
    s_barrier
    v_add_u32 v6, 32768, v4
    v_add_u32 v7, 32768, v5
    v_exp_f32 v64, v64
    v_exp_f32 v65, v65
    v_smfmac_f32_32x32x32_bf16 v[48:63], v[36:39], v[88:95], v40
    v_exp_f32 v66, v66
    v_exp_f32 v67, v67
    v_exp_f32 v68, v68
    v_exp_f32 v69, v69
    v_mfma_f32_32x32x16_bf16 v[80:95], v[20:23], v[12:15], 0
    ds_read_b128 v[16:19], v42 offset:34816
    s_setprio 3
    ds_read_b64_tr_b16 v[96:97], v6 offset:0
    ds_read_b64_tr_b16 v[98:99], v6 offset:1024
    v_exp_f32 v70, v70
    buffer_load_dwordx4 a[96:99], v1, s[24:27], s74 offen offset:0 sc1
    s_mov_b64 exec, s[40:41]
    ds_read_b128 v[32:35], v43 offset:33792
    ds_read_b128 v[36:39], v43 offset:34304
    s_mov_b64 exec, -1
    v_exp_f32 v71, v71
    v_exp_f32 v72, v72
    v_exp_f32 v73, v73
    v_exp_f32 v74, v74
    s_waitcnt lgkmcnt(2)
    v_mfma_f32_32x32x16_bf16 a[0:15], v[96:99], a[80:83], a[0:15]
    v_exp_f32 v75, v75
    v_exp_f32 v76, v76
    v_exp_f32 v77, v77
    v_exp_f32 v78, v78
    v_exp_f32 v79, v79
    v_smfmac_f32_32x32x32_bf16 v[48:63], v[24:27], v[64:71], v40
    v_exp_f32 v80, v80
    v_exp_f32 v81, v81
    v_smfmac_f32_32x32x32_bf16 v[48:63], v[28:31], v[72:79], v40
    v_exp_f32 v82, v82
    v_exp_f32 v83, v83
    v_exp_f32 v84, v84
    v_exp_f32 v85, v85
    v_mfma_f32_32x32x16_bf16 v[64:79], v[16:19], v[12:15], 0
    ds_read_b128 v[20:23], v42 offset:35840
    s_setprio 2
    ds_read_b64_tr_b16 v[100:101], v7 offset:0
    ds_read_b64_tr_b16 v[102:103], v7 offset:1024
    v_exp_f32 v86, v86
    buffer_load_dwordx4 a[100:103], v1, s[24:27], s74 offen offset:1024 sc1
    s_add_u32 s74, s74, 8192
    s_mov_b64 exec, s[40:41]
    ds_read_b128 v[24:27], v43 offset:34816
    ds_read_b128 v[28:31], v43 offset:35328
    s_mov_b64 exec, -1
    v_exp_f32 v87, v87
    v_exp_f32 v88, v88
    v_exp_f32 v89, v89
    v_exp_f32 v90, v90
    s_waitcnt lgkmcnt(2)
    v_mfma_f32_32x32x16_bf16 a[16:31], v[100:103], a[80:83], a[16:31]
    v_exp_f32 v91, v91
    v_exp_f32 v92, v92
    v_exp_f32 v93, v93
    v_exp_f32 v94, v94
    v_exp_f32 v95, v95
    v_smfmac_f32_32x32x32_bf16 v[48:63], v[32:35], v[80:87], v40
    v_exp_f32 v64, v64
    v_exp_f32 v65, v65
    v_smfmac_f32_32x32x32_bf16 v[48:63], v[36:39], v[88:95], v40
    v_exp_f32 v66, v66
    v_exp_f32 v67, v67
    v_exp_f32 v68, v68
    v_exp_f32 v69, v69
    v_mfma_f32_32x32x16_bf16 v[80:95], v[20:23], v[12:15], 0
    ds_read_b128 v[16:19], v42 offset:40960
    s_setprio 1
    ds_read_b64_tr_b16 v[104:105], v6 offset:2048
    ds_read_b64_tr_b16 v[106:107], v6 offset:3072
    v_exp_f32 v70, v70
    s_add_u32 s76, s72, 1179648
    s_add_u32 m0, s73, 16384
    s_nop 0
    buffer_load_dwordx4 v8, s[16:19], s76 offen lds
    s_mov_b64 exec, s[40:41]
    ds_read_b128 v[32:35], v43 offset:35840
    ds_read_b128 v[36:39], v43 offset:36352
    s_mov_b64 exec, -1
    v_exp_f32 v71, v71
    v_exp_f32 v72, v72
    v_exp_f32 v73, v73
    v_exp_f32 v74, v74
    s_waitcnt lgkmcnt(2)
    v_mfma_f32_32x32x16_bf16 a[0:15], v[104:107], a[84:87], a[0:15]
    v_exp_f32 v75, v75
    v_exp_f32 v76, v76
    v_exp_f32 v77, v77
    v_exp_f32 v78, v78
    v_exp_f32 v79, v79
    v_smfmac_f32_32x32x32_bf16 v[48:63], v[24:27], v[64:71], v40
    v_exp_f32 v80, v80
    v_exp_f32 v81, v81
    v_smfmac_f32_32x32x32_bf16 v[48:63], v[28:31], v[72:79], v40
    v_exp_f32 v82, v82
    v_exp_f32 v83, v83
    v_exp_f32 v84, v84
    v_exp_f32 v85, v85
    v_mfma_f32_32x32x16_bf16 v[64:79], v[16:19], v[12:15], 0
    ds_read_b128 v[20:23], v42 offset:41984
    s_setprio 0
    ds_read_b64_tr_b16 v[108:109], v7 offset:2048
    ds_read_b64_tr_b16 v[110:111], v7 offset:3072
    v_exp_f32 v86, v86
    s_add_u32 s76, s72, 1187840
    s_add_u32 m0, s73, 17408
    s_nop 0
    buffer_load_dwordx4 v8, s[16:19], s76 offen lds
    s_mov_b64 exec, s[40:41]
    ds_read_b128 v[24:27], v43 offset:40960
    ds_read_b128 v[28:31], v43 offset:41472
    s_mov_b64 exec, -1
    v_exp_f32 v87, v87
    v_exp_f32 v88, v88
    v_exp_f32 v89, v89
    v_exp_f32 v90, v90
    s_waitcnt lgkmcnt(2)
    v_mfma_f32_32x32x16_bf16 a[16:31], v[108:111], a[84:87], a[16:31]
    v_exp_f32 v91, v91
    v_exp_f32 v92, v92
    v_exp_f32 v93, v93
    v_exp_f32 v94, v94
    v_exp_f32 v95, v95
    v_smfmac_f32_32x32x32_bf16 v[48:63], v[32:35], v[80:87], v40
    s_waitcnt vmcnt(8)
    s_barrier
    v_add_u32 v6, 49152, v4
    v_add_u32 v7, 49152, v5
    v_exp_f32 v64, v64
    v_exp_f32 v65, v65
    v_smfmac_f32_32x32x32_bf16 v[48:63], v[36:39], v[88:95], v40
    v_exp_f32 v66, v66
    v_exp_f32 v67, v67
    v_exp_f32 v68, v68
    v_exp_f32 v69, v69
    v_mfma_f32_32x32x16_bf16 v[80:95], v[20:23], v[12:15], 0
    ds_read_b128 v[16:19], v42 offset:43008
    s_setprio 3
    ds_read_b64_tr_b16 v[96:97], v6 offset:0
    ds_read_b64_tr_b16 v[98:99], v6 offset:1024
    v_exp_f32 v70, v70
    buffer_load_dwordx4 a[104:107], v1, s[24:27], s74 offen offset:0 sc1
    buffer_load_dwordx4 a[108:111], v1, s[24:27], s74 offen offset:1024 sc1
    s_add_u32 s74, s74, 8192
    s_mov_b64 exec, s[40:41]
    ds_read_b128 v[32:35], v43 offset:41984
    ds_read_b128 v[36:39], v43 offset:42496
    s_mov_b64 exec, -1
    v_exp_f32 v71, v71
    v_exp_f32 v72, v72
    v_exp_f32 v73, v73
    v_exp_f32 v74, v74
    s_waitcnt lgkmcnt(2)
    v_mfma_f32_32x32x16_bf16 a[0:15], v[96:99], a[88:91], a[0:15]
    v_exp_f32 v75, v75
    v_exp_f32 v76, v76
    v_exp_f32 v77, v77
    v_exp_f32 v78, v78
    v_exp_f32 v79, v79
    v_smfmac_f32_32x32x32_bf16 v[48:63], v[24:27], v[64:71], v40
    v_exp_f32 v80, v80
    v_exp_f32 v81, v81
    v_smfmac_f32_32x32x32_bf16 v[48:63], v[28:31], v[72:79], v40
    v_exp_f32 v82, v82
    v_exp_f32 v83, v83
    v_exp_f32 v84, v84
    v_exp_f32 v85, v85
    v_mfma_f32_32x32x16_bf16 v[64:79], v[16:19], v[12:15], 0
    ds_read_b128 v[20:23], v42 offset:44032
    s_setprio 2
    ds_read_b64_tr_b16 v[100:101], v7 offset:0
    ds_read_b64_tr_b16 v[102:103], v7 offset:1024
    v_exp_f32 v86, v86
    s_add_u32 s76, s72, 1310720
    s_add_u32 m0, s73, 32768
    s_nop 0
    buffer_load_dwordx4 v8, s[16:19], s76 offen lds
    s_add_u32 s76, s72, 1318912
    s_add_u32 m0, s73, 33792
    s_nop 0
    buffer_load_dwordx4 v8, s[16:19], s76 offen lds
    s_mov_b64 exec, s[40:41]
    ds_read_b128 v[24:27], v43 offset:43008
    ds_read_b128 v[28:31], v43 offset:43520
    s_mov_b64 exec, -1
    v_exp_f32 v87, v87
    v_exp_f32 v88, v88
    v_exp_f32 v89, v89
    v_exp_f32 v90, v90
    s_waitcnt lgkmcnt(2)
    v_mfma_f32_32x32x16_bf16 a[16:31], v[100:103], a[88:91], a[16:31]
    v_exp_f32 v91, v91
    v_exp_f32 v92, v92
    v_exp_f32 v93, v93
    v_exp_f32 v94, v94
    v_exp_f32 v95, v95
    v_smfmac_f32_32x32x32_bf16 v[48:63], v[32:35], v[80:87], v40
    v_exp_f32 v64, v64
    v_exp_f32 v65, v65
    v_smfmac_f32_32x32x32_bf16 v[48:63], v[36:39], v[88:95], v40
    v_exp_f32 v66, v66
    v_exp_f32 v67, v67
    v_exp_f32 v68, v68
    v_exp_f32 v69, v69
    v_mfma_f32_32x32x16_bf16 v[80:95], v[20:23], v[12:15], 0
    ds_read_b128 v[16:19], v42 offset:49152
    s_setprio 1
    ds_read_b64_tr_b16 v[104:105], v6 offset:2048
    ds_read_b64_tr_b16 v[106:107], v6 offset:3072
    v_exp_f32 v70, v70
    s_add_u32 s76, s72, 393216
    s_add_u32 m0, s73, 114688
    s_nop 0
    buffer_load_dwordx4 v8, s[20:23], s76 offen lds
    s_mov_b64 exec, s[40:41]
    ds_read_b128 v[32:35], v43 offset:44032
    ds_read_b128 v[36:39], v43 offset:44544
    s_mov_b64 exec, -1
    v_exp_f32 v71, v71
    v_exp_f32 v72, v72
    v_exp_f32 v73, v73
    v_exp_f32 v74, v74
    s_waitcnt lgkmcnt(2)
    v_mfma_f32_32x32x16_bf16 a[0:15], v[104:107], a[92:95], a[0:15]
    v_exp_f32 v75, v75
    v_exp_f32 v76, v76
    v_exp_f32 v77, v77
    v_exp_f32 v78, v78
    v_exp_f32 v79, v79
    v_smfmac_f32_32x32x32_bf16 v[48:63], v[24:27], v[64:71], v40
    v_exp_f32 v80, v80
    v_exp_f32 v81, v81
    v_smfmac_f32_32x32x32_bf16 v[48:63], v[28:31], v[72:79], v40
    v_exp_f32 v82, v82
    v_exp_f32 v83, v83
    v_exp_f32 v84, v84
    v_exp_f32 v85, v85
    v_mfma_f32_32x32x16_bf16 v[64:79], v[16:19], v[12:15], 0
    ds_read_b128 v[20:23], v42 offset:50176
    s_setprio 0
    ds_read_b64_tr_b16 v[108:109], v7 offset:2048
    ds_read_b64_tr_b16 v[110:111], v7 offset:3072
    v_exp_f32 v86, v86
    s_add_u32 s76, s72, 401408
    s_add_u32 m0, s73, 115712
    s_nop 0
    buffer_load_dwordx4 v8, s[20:23], s76 offen lds
    s_mov_b64 exec, s[40:41]
    ds_read_b128 v[24:27], v43 offset:49152
    ds_read_b128 v[28:31], v43 offset:49664
    s_mov_b64 exec, -1
    v_exp_f32 v87, v87
    v_exp_f32 v88, v88
    v_exp_f32 v89, v89
    v_exp_f32 v90, v90
    s_waitcnt lgkmcnt(2)
    v_mfma_f32_32x32x16_bf16 a[16:31], v[108:111], a[92:95], a[16:31]
    v_exp_f32 v91, v91
    v_exp_f32 v92, v92
    v_exp_f32 v93, v93
    v_exp_f32 v94, v94
    v_exp_f32 v95, v95
    v_smfmac_f32_32x32x32_bf16 v[48:63], v[32:35], v[80:87], v40
    s_waitcnt vmcnt(8)
    s_barrier
    v_add_u32 v6, 0, v4
    v_add_u32 v7, 0, v5
    v_exp_f32 v64, v64
    v_exp_f32 v65, v65
    v_smfmac_f32_32x32x32_bf16 v[48:63], v[36:39], v[88:95], v40
    v_exp_f32 v66, v66
    v_exp_f32 v67, v67
    v_exp_f32 v68, v68
    v_exp_f32 v69, v69
    v_mfma_f32_32x32x16_bf16 v[80:95], v[20:23], v[12:15], 0
    ds_read_b128 v[16:19], v42 offset:51200
    s_setprio 3
    ds_read_b64_tr_b16 v[96:97], v6 offset:0
    ds_read_b64_tr_b16 v[98:99], v6 offset:1024
    v_exp_f32 v70, v70
    s_cmp_ge_u32 s3, 6
    s_cselect_b32 s74, 0x1000000, s74
    buffer_load_dwordx4 a[112:115], v1, s[24:27], s74 offen offset:0 sc1
    s_mov_b64 exec, s[40:41]
    ds_read_b128 v[32:35], v43 offset:50176
    ds_read_b128 v[36:39], v43 offset:50688
    s_mov_b64 exec, -1
    v_exp_f32 v71, v71
    v_exp_f32 v72, v72
    v_exp_f32 v73, v73
    v_exp_f32 v74, v74
    s_waitcnt lgkmcnt(2)
    v_mfma_f32_32x32x16_bf16 a[0:15], v[96:99], a[96:99], a[0:15]
    v_exp_f32 v75, v75
    v_exp_f32 v76, v76
    v_exp_f32 v77, v77
    v_exp_f32 v78, v78
    v_exp_f32 v79, v79
    v_smfmac_f32_32x32x32_bf16 v[48:63], v[24:27], v[64:71], v40
    v_exp_f32 v80, v80
    v_exp_f32 v81, v81
    v_smfmac_f32_32x32x32_bf16 v[48:63], v[28:31], v[72:79], v40
    v_exp_f32 v82, v82
    v_exp_f32 v83, v83
    v_exp_f32 v84, v84
    v_exp_f32 v85, v85
    v_mfma_f32_32x32x16_bf16 v[64:79], v[16:19], v[12:15], 0
    ds_read_b128 v[20:23], v42 offset:52224
    s_setprio 2
    ds_read_b64_tr_b16 v[100:101], v7 offset:0
    ds_read_b64_tr_b16 v[102:103], v7 offset:1024
    v_exp_f32 v86, v86
    buffer_load_dwordx4 a[116:119], v1, s[24:27], s74 offen offset:1024 sc1
    s_mov_b64 exec, s[40:41]
    ds_read_b128 v[24:27], v43 offset:51200
    ds_read_b128 v[28:31], v43 offset:51712
    s_mov_b64 exec, -1
    v_exp_f32 v87, v87
    v_exp_f32 v88, v88
    v_exp_f32 v89, v89
    v_exp_f32 v90, v90
    s_waitcnt lgkmcnt(2)
    v_mfma_f32_32x32x16_bf16 a[16:31], v[100:103], a[96:99], a[16:31]
    v_exp_f32 v91, v91
    v_exp_f32 v92, v92
    v_exp_f32 v93, v93
    v_exp_f32 v94, v94
    v_exp_f32 v95, v95
    v_smfmac_f32_32x32x32_bf16 v[48:63], v[32:35], v[80:87], v40
    v_exp_f32 v64, v64
    v_exp_f32 v65, v65
    v_smfmac_f32_32x32x32_bf16 v[48:63], v[36:39], v[88:95], v40
    v_exp_f32 v66, v66
    v_exp_f32 v67, v67
    v_exp_f32 v68, v68
    v_exp_f32 v69, v69
    v_mfma_f32_32x32x16_bf16 v[80:95], v[20:23], v[12:15], 0
    ds_read_b128 v[16:19], v42 offset:57344
    s_setprio 1
    ds_read_b64_tr_b16 v[104:105], v6 offset:2048
    ds_read_b64_tr_b16 v[106:107], v6 offset:3072
    v_exp_f32 v70, v70
    s_mov_b64 exec, s[40:41]
    ds_read_b128 v[32:35], v43 offset:52224
    ds_read_b128 v[36:39], v43 offset:52736
    s_mov_b64 exec, -1
    v_exp_f32 v71, v71
    v_exp_f32 v72, v72
    v_exp_f32 v73, v73
    v_exp_f32 v74, v74
    s_waitcnt lgkmcnt(2)
    v_mfma_f32_32x32x16_bf16 a[0:15], v[104:107], a[100:103], a[0:15]
    v_exp_f32 v75, v75
    v_exp_f32 v76, v76
    v_exp_f32 v77, v77
    v_exp_f32 v78, v78
    v_exp_f32 v79, v79
    v_smfmac_f32_32x32x32_bf16 v[48:63], v[24:27], v[64:71], v40
    v_exp_f32 v80, v80
    v_exp_f32 v81, v81
    v_smfmac_f32_32x32x32_bf16 v[48:63], v[28:31], v[72:79], v40
    v_exp_f32 v82, v82
    v_exp_f32 v83, v83
    v_exp_f32 v84, v84
    v_exp_f32 v85, v85
    v_mfma_f32_32x32x16_bf16 v[64:79], v[16:19], v[12:15], 0
    ds_read_b128 v[20:23], v42 offset:58368
    s_setprio 0
    ds_read_b64_tr_b16 v[108:109], v7 offset:2048
    ds_read_b64_tr_b16 v[110:111], v7 offset:3072
    v_exp_f32 v86, v86
    s_mov_b64 exec, s[40:41]
    ds_read_b128 v[24:27], v43 offset:57344
    ds_read_b128 v[28:31], v43 offset:57856
    s_mov_b64 exec, -1
    v_exp_f32 v87, v87
    v_exp_f32 v88, v88
    v_exp_f32 v89, v89
    v_exp_f32 v90, v90
    s_waitcnt lgkmcnt(2)
    v_mfma_f32_32x32x16_bf16 a[16:31], v[108:111], a[100:103], a[16:31]
    v_exp_f32 v91, v91
    v_exp_f32 v92, v92
    v_exp_f32 v93, v93
    v_exp_f32 v94, v94
    v_exp_f32 v95, v95
    v_smfmac_f32_32x32x32_bf16 v[48:63], v[32:35], v[80:87], v40
    s_waitcnt vmcnt(2)
    s_barrier
    v_add_u32 v6, 16384, v4
    v_add_u32 v7, 16384, v5
    v_exp_f32 v64, v64
    v_exp_f32 v65, v65
    v_smfmac_f32_32x32x32_bf16 v[48:63], v[36:39], v[88:95], v40
    v_exp_f32 v66, v66
    v_exp_f32 v67, v67
    v_exp_f32 v68, v68
    v_exp_f32 v69, v69
    v_mfma_f32_32x32x16_bf16 v[80:95], v[20:23], v[12:15], 0
    ds_read_b128 v[16:19], v42 offset:59392
    s_setprio 3
    ds_read_b64_tr_b16 v[96:97], v6 offset:0
    ds_read_b64_tr_b16 v[98:99], v6 offset:1024
    v_exp_f32 v70, v70
    s_mov_b64 exec, s[40:41]
    ds_read_b128 v[32:35], v43 offset:58368
    ds_read_b128 v[36:39], v43 offset:58880
    s_mov_b64 exec, -1
    v_exp_f32 v71, v71
    v_exp_f32 v72, v72
    v_exp_f32 v73, v73
    v_exp_f32 v74, v74
    s_waitcnt lgkmcnt(2)
    v_mfma_f32_32x32x16_bf16 a[0:15], v[96:99], a[104:107], a[0:15]
    v_exp_f32 v75, v75
    v_exp_f32 v76, v76
    v_exp_f32 v77, v77
    v_exp_f32 v78, v78
    v_exp_f32 v79, v79
    v_smfmac_f32_32x32x32_bf16 v[48:63], v[24:27], v[64:71], v40
    v_exp_f32 v80, v80
    v_exp_f32 v81, v81
    v_smfmac_f32_32x32x32_bf16 v[48:63], v[28:31], v[72:79], v40
    v_exp_f32 v82, v82
    v_exp_f32 v83, v83
    v_exp_f32 v84, v84
    v_exp_f32 v85, v85
    v_mfma_f32_32x32x16_bf16 v[64:79], v[16:19], v[12:15], 0
    ds_read_b128 v[20:23], v42 offset:60416
    s_setprio 2
    ds_read_b64_tr_b16 v[100:101], v7 offset:0
    ds_read_b64_tr_b16 v[102:103], v7 offset:1024
    v_exp_f32 v86, v86
    s_mov_b64 exec, s[40:41]
    ds_read_b128 v[24:27], v43 offset:59392
    ds_read_b128 v[28:31], v43 offset:59904
    s_mov_b64 exec, -1
    v_exp_f32 v87, v87
    v_exp_f32 v88, v88
    v_exp_f32 v89, v89
    v_exp_f32 v90, v90
    s_waitcnt lgkmcnt(2)
    v_mfma_f32_32x32x16_bf16 a[16:31], v[100:103], a[104:107], a[16:31]
    v_exp_f32 v91, v91
    v_exp_f32 v92, v92
    v_exp_f32 v93, v93
    v_exp_f32 v94, v94
    v_exp_f32 v95, v95
    v_smfmac_f32_32x32x32_bf16 v[48:63], v[32:35], v[80:87], v40
    v_exp_f32 v64, v64
    v_exp_f32 v65, v65
    v_smfmac_f32_32x32x32_bf16 v[48:63], v[36:39], v[88:95], v40
    v_exp_f32 v66, v66
    v_exp_f32 v67, v67
    v_exp_f32 v68, v68
    v_exp_f32 v69, v69
    v_mfma_f32_32x32x16_bf16 v[80:95], v[20:23], v[12:15], 0
    s_setprio 1
    ds_read_b64_tr_b16 v[104:105], v6 offset:2048
    ds_read_b64_tr_b16 v[106:107], v6 offset:3072
    v_exp_f32 v70, v70
    s_mov_b64 exec, s[40:41]
    ds_read_b128 v[32:35], v43 offset:60416
    ds_read_b128 v[36:39], v43 offset:60928
    s_mov_b64 exec, -1
    v_exp_f32 v71, v71
    v_exp_f32 v72, v72
    v_exp_f32 v73, v73
    v_exp_f32 v74, v74
    s_waitcnt lgkmcnt(2)
    v_mfma_f32_32x32x16_bf16 a[0:15], v[104:107], a[108:111], a[0:15]
    v_exp_f32 v75, v75
    v_exp_f32 v76, v76
    v_exp_f32 v77, v77
    v_exp_f32 v78, v78
    v_exp_f32 v79, v79
    v_smfmac_f32_32x32x32_bf16 v[48:63], v[24:27], v[64:71], v40
    v_exp_f32 v80, v80
    v_exp_f32 v81, v81
    v_smfmac_f32_32x32x32_bf16 v[48:63], v[28:31], v[72:79], v40
    v_exp_f32 v82, v82
    v_exp_f32 v83, v83
    v_exp_f32 v84, v84
    v_exp_f32 v85, v85
    s_setprio 0
    ds_read_b64_tr_b16 v[108:109], v7 offset:2048
    ds_read_b64_tr_b16 v[110:111], v7 offset:3072
    v_exp_f32 v86, v86
    v_exp_f32 v87, v87
    v_exp_f32 v88, v88
    v_exp_f32 v89, v89
    v_exp_f32 v90, v90
    s_waitcnt lgkmcnt(0)
    v_mfma_f32_32x32x16_bf16 a[16:31], v[108:111], a[108:111], a[16:31]
    v_exp_f32 v91, v91
    v_exp_f32 v92, v92
    v_exp_f32 v93, v93
    v_exp_f32 v94, v94
    v_exp_f32 v95, v95
    v_smfmac_f32_32x32x32_bf16 v[48:63], v[32:35], v[80:87], v40
    s_setprio 0
    s_nop 1
    v_smfmac_f32_32x32x32_bf16 v[48:63], v[36:39], v[88:95], v40
    s_nop 7
    s_nop 7
    v_mov_b32 v9, 0x2b800000
    v_cmp_nge_f32 vcc, v56, v9
    v_mov_b32 v9, 0x53800000
    v_cmp_nle_f32 s[76:77], v56, v9
    v_max3_f32 v9, abs(v48), abs(v49), abs(v50)
    v_max3_f32 v9, v9, abs(v51), abs(v52)
    v_max3_f32 v9, v9, abs(v53), abs(v54)
    v_max_f32 v9, v9, abs(v55)
    v_mov_b32 v2, 0x7f000000
    v_cmp_nlt_f32 s[78:79], v9, v2
    s_nop 1
    s_or_b64 vcc, vcc, s[76:77]
    s_or_b64 vcc, vcc, s[78:79]
    s_cbranch_vccnz L_fallback
L_norm:
    v_rcp_f32 v9, v56
    s_lshl_b32 s76, s45, 3
    s_add_u32 s76, s76, s3
    v_mul_f32 v9, v9, v10
    s_lshl_b32 s76, s76, 5
    s_add_u32 s76, s76, s44
    v_mul_f32 v48, v9, v48
    v_mul_f32 v49, v9, v49
    v_mul_f32 v50, v9, v50
    v_mul_f32 v51, v9, v51
    v_mul_f32 v52, v9, v52
    v_mul_f32 v53, v9, v53
    v_mul_f32 v54, v9, v54
    v_mul_f32 v55, v9, v55
    s_lshl_b32 s76, s76, 10
    s_add_u32 s76, s76, 6291456
    v_cvt_pk_bf16_f32 v48, v48, v49
    v_cvt_pk_bf16_f32 v49, v50, v51
    v_cvt_pk_bf16_f32 v50, v52, v53
    v_cvt_pk_bf16_f32 v51, v54, v55
    v_min_u32 v48, -2, v48
    v_min_u32 v49, -2, v49
    v_min_u32 v50, -2, v50
    v_min_u32 v51, -2, v51
    buffer_store_dwordx4 v[48:51], v1, s[24:27], s76 offen sc1
    v_add_u32 v6, 32768, v4
    v_add_u32 v7, 32768, v5
    ds_read_b64_tr_b16 v[96:97], v6 offset:0
    ds_read_b64_tr_b16 v[98:99], v6 offset:1024
    ds_read_b64_tr_b16 v[100:101], v7 offset:0
    ds_read_b64_tr_b16 v[102:103], v7 offset:1024
    ds_read_b64_tr_b16 v[104:105], v6 offset:2048
    ds_read_b64_tr_b16 v[106:107], v6 offset:3072
    ds_read_b64_tr_b16 v[108:109], v7 offset:2048
    ds_read_b64_tr_b16 v[110:111], v7 offset:3072
    s_waitcnt vmcnt(1)
    s_waitcnt lgkmcnt(6)
    v_mfma_f32_32x32x16_bf16 a[0:15], v[96:99], a[112:115], a[0:15]
    s_waitcnt lgkmcnt(4)
    v_mfma_f32_32x32x16_bf16 a[16:31], v[100:103], a[112:115], a[16:31]
    s_waitcnt lgkmcnt(2)
    v_mfma_f32_32x32x16_bf16 a[0:15], v[104:107], a[116:119], a[0:15]
    s_waitcnt lgkmcnt(0)
    v_mfma_f32_32x32x16_bf16 a[16:31], v[108:111], a[116:119], a[16:31]
    v_add_u32 v6, 65536, v4
    v_add_u32 v7, 65536, v5
    ds_read_b64_tr_b16 a[32:33], v6 offset:0
    ds_read_b64_tr_b16 a[34:35], v6 offset:1024
    ds_read_b64_tr_b16 a[36:37], v7 offset:0
    ds_read_b64_tr_b16 a[38:39], v7 offset:1024
    ds_read_b64_tr_b16 a[40:41], v6 offset:2048
    ds_read_b64_tr_b16 a[42:43], v6 offset:3072
    ds_read_b64_tr_b16 a[44:45], v7 offset:2048
    ds_read_b64_tr_b16 a[46:47], v7 offset:3072
    v_add_u32 v6, 81920, v4
    v_add_u32 v7, 81920, v5
    ds_read_b64_tr_b16 a[48:49], v6 offset:0
    ds_read_b64_tr_b16 a[50:51], v6 offset:1024
    ds_read_b64_tr_b16 a[52:53], v7 offset:0
    ds_read_b64_tr_b16 a[54:55], v7 offset:1024
    ds_read_b64_tr_b16 a[56:57], v6 offset:2048
    ds_read_b64_tr_b16 a[58:59], v6 offset:3072
    ds_read_b64_tr_b16 a[60:61], v7 offset:2048
    ds_read_b64_tr_b16 a[62:63], v7 offset:3072
    v_add_u32 v6, 98304, v4
    v_add_u32 v7, 98304, v5
    ds_read_b64_tr_b16 a[64:65], v6 offset:0
    ds_read_b64_tr_b16 a[66:67], v6 offset:1024
    ds_read_b64_tr_b16 a[68:69], v7 offset:0
    ds_read_b64_tr_b16 a[70:71], v7 offset:1024
    ds_read_b64_tr_b16 a[72:73], v6 offset:2048
    ds_read_b64_tr_b16 a[74:75], v6 offset:3072
    ds_read_b64_tr_b16 a[76:77], v7 offset:2048
    ds_read_b64_tr_b16 a[78:79], v7 offset:3072
    v_add_u32 v6, 114688, v4
    v_add_u32 v7, 114688, v5
    ds_read_b64_tr_b16 a[80:81], v6 offset:0
    ds_read_b64_tr_b16 a[82:83], v6 offset:1024
    ds_read_b64_tr_b16 a[84:85], v7 offset:0
    ds_read_b64_tr_b16 a[86:87], v7 offset:1024
    ds_read_b64_tr_b16 a[88:89], v6 offset:2048
    ds_read_b64_tr_b16 a[90:91], v6 offset:3072
    ds_read_b64_tr_b16 a[92:93], v7 offset:2048
    ds_read_b64_tr_b16 a[94:95], v7 offset:3072
    v_sub_f32 v8, 1.0, v11
    v_accvgpr_read_b32 v64, a0
    v_accvgpr_read_b32 v65, a1
    v_accvgpr_read_b32 v66, a2
    v_accvgpr_read_b32 v67, a3
    v_accvgpr_read_b32 v68, a4
    v_accvgpr_read_b32 v69, a5
    v_accvgpr_read_b32 v70, a6
    v_accvgpr_read_b32 v71, a7
    v_accvgpr_read_b32 v72, a8
    v_accvgpr_read_b32 v73, a9
    v_accvgpr_read_b32 v74, a10
    v_accvgpr_read_b32 v75, a11
    v_accvgpr_read_b32 v76, a12
    v_accvgpr_read_b32 v77, a13
    v_accvgpr_read_b32 v78, a14
    v_accvgpr_read_b32 v79, a15
    v_accvgpr_read_b32 v80, a16
    v_accvgpr_read_b32 v81, a17
    v_accvgpr_read_b32 v82, a18
    v_accvgpr_read_b32 v83, a19
    v_accvgpr_read_b32 v84, a20
    v_accvgpr_read_b32 v85, a21
    v_accvgpr_read_b32 v86, a22
    v_accvgpr_read_b32 v87, a23
    v_accvgpr_read_b32 v88, a24
    v_accvgpr_read_b32 v89, a25
    v_accvgpr_read_b32 v90, a26
    v_accvgpr_read_b32 v91, a27
    v_accvgpr_read_b32 v92, a28
    v_accvgpr_read_b32 v93, a29
    v_accvgpr_read_b32 v94, a30
    v_accvgpr_read_b32 v95, a31
    v_mul_f32 v64, v8, v64
    v_mul_f32 v65, v8, v65
    v_mul_f32 v66, v8, v66
    v_mul_f32 v67, v8, v67
    v_mul_f32 v68, v8, v68
    v_mul_f32 v69, v8, v69
    v_mul_f32 v70, v8, v70
    v_mul_f32 v71, v8, v71
    v_mul_f32 v72, v8, v72
    v_mul_f32 v73, v8, v73
    v_mul_f32 v74, v8, v74
    v_mul_f32 v75, v8, v75
    v_mul_f32 v76, v8, v76
    v_mul_f32 v77, v8, v77
    v_mul_f32 v78, v8, v78
    v_mul_f32 v79, v8, v79
    v_mul_f32 v80, v8, v80
    v_mul_f32 v81, v8, v81
    v_mul_f32 v82, v8, v82
    v_mul_f32 v83, v8, v83
    v_mul_f32 v84, v8, v84
    v_mul_f32 v85, v8, v85
    v_mul_f32 v86, v8, v86
    v_mul_f32 v87, v8, v87
    v_mul_f32 v88, v8, v88
    v_mul_f32 v89, v8, v89
    v_mul_f32 v90, v8, v90
    v_mul_f32 v91, v8, v91
    v_mul_f32 v92, v8, v92
    v_mul_f32 v93, v8, v93
    v_mul_f32 v94, v8, v94
    v_mul_f32 v95, v8, v95
    v_bfe_u32 v2, v0, 3, 1
    v_bfe_u32 v3, v0, 2, 1
    v_xor_b32 v3, v3, v2
    v_and_b32 v4, 3, v0
    v_lshl_add_u32 v4, v4, 1, v3
    v_bfe_u32 v6, v0, 4, 1
    v_bfe_u32 v7, v0, 5, 1
    v_mul_u32_u24 v5, 1056, v4
    v_lshl_add_u32 v5, v7, 9, v5
    v_lshl_add_u32 v5, v6, 7, v5
    v_lshl_add_u32 v5, v2, 4, v5
    s_lshr_b32 s76, s3, 2
    s_mul_i32 s76, s76, 8448
    s_and_b32 s77, s3, 3
    s_lshl_b32 s77, s77, 5
    s_add_u32 s76, s76, s77
    v_add_u32 v5, s76, v5
    v_bfe_u32 v3, v0, 4, 2
    v_lshl_add_u32 v3, v2, 2, v3
    s_lshl_b32 s76, s3, 3
    v_add_u32 v3, s76, v3
    v_lshlrev_b32 v3, 10, v3
    v_lshl_add_u32 v3, v4, 4, v3
    s_mul_i32 s76, s3, 8448
    s_mov_b32 m0, s76
    s_waitcnt lgkmcnt(0)
    s_barrier
    s_mov_b32 s80, 400000
L_opoll:
    s_mov_b32 s76, s75
    buffer_load_dwordx4 v[16:19], v1, s[24:27], s76 offen offset:0 sc1
    buffer_load_dwordx4 v[20:23], v1, s[24:27], s76 offen offset:1024 sc1
    s_add_u32 s76, s76, 8192
    buffer_load_dwordx4 v[24:27], v1, s[24:27], s76 offen offset:0 sc1
    buffer_load_dwordx4 v[28:31], v1, s[24:27], s76 offen offset:1024 sc1
    s_add_u32 s76, s76, 8192
    buffer_load_dwordx4 v[32:35], v1, s[24:27], s76 offen offset:0 sc1
    buffer_load_dwordx4 v[36:39], v1, s[24:27], s76 offen offset:1024 sc1
    s_add_u32 s76, s76, 8192
    buffer_load_dwordx4 v[40:43], v1, s[24:27], s76 offen offset:0 sc1
    buffer_load_dwordx4 v[44:47], v1, s[24:27], s76 offen offset:1024 sc1
L_ochk:
    s_waitcnt vmcnt(7)
    v_max3_u32 v9, v16, v17, v18
    v_max_u32 v9, v9, v19
    v_cmp_eq_u32 s[48:49], -1, v9
    v_mfma_f32_32x32x16_bf16 v[64:79], a[32:35], v[16:19], v[64:79]
    v_mfma_f32_32x32x16_bf16 v[80:95], a[36:39], v[16:19], v[80:95]
    s_waitcnt vmcnt(6)
    v_max3_u32 v9, v20, v21, v22
    v_max_u32 v9, v9, v23
    v_cmp_eq_u32 s[50:51], -1, v9
    v_mfma_f32_32x32x16_bf16 v[64:79], a[40:43], v[20:23], v[64:79]
    v_mfma_f32_32x32x16_bf16 v[80:95], a[44:47], v[20:23], v[80:95]
    s_mov_b64 s[64:65], s[48:49]
    s_waitcnt vmcnt(5)
    v_max3_u32 v9, v24, v25, v26
    v_max_u32 v9, v9, v27
    v_cmp_eq_u32 s[52:53], -1, v9
    v_mfma_f32_32x32x16_bf16 v[64:79], a[48:51], v[24:27], v[64:79]
    v_mfma_f32_32x32x16_bf16 v[80:95], a[52:55], v[24:27], v[80:95]
    s_or_b64 s[64:65], s[64:65], s[50:51]
    s_waitcnt vmcnt(4)
    v_max3_u32 v9, v28, v29, v30
    v_max_u32 v9, v9, v31
    v_cmp_eq_u32 s[54:55], -1, v9
    v_mfma_f32_32x32x16_bf16 v[64:79], a[56:59], v[28:31], v[64:79]
    v_mfma_f32_32x32x16_bf16 v[80:95], a[60:63], v[28:31], v[80:95]
    s_or_b64 s[64:65], s[64:65], s[52:53]
    s_waitcnt vmcnt(3)
    v_max3_u32 v9, v32, v33, v34
    v_max_u32 v9, v9, v35
    v_cmp_eq_u32 s[56:57], -1, v9
    v_mfma_f32_32x32x16_bf16 v[64:79], a[64:67], v[32:35], v[64:79]
    v_mfma_f32_32x32x16_bf16 v[80:95], a[68:71], v[32:35], v[80:95]
    s_or_b64 s[64:65], s[64:65], s[54:55]
    s_waitcnt vmcnt(2)
    v_max3_u32 v9, v36, v37, v38
    v_max_u32 v9, v9, v39
    v_cmp_eq_u32 s[58:59], -1, v9
    v_mfma_f32_32x32x16_bf16 v[64:79], a[72:75], v[36:39], v[64:79]
    v_mfma_f32_32x32x16_bf16 v[80:95], a[76:79], v[36:39], v[80:95]
    s_or_b64 s[64:65], s[64:65], s[56:57]
    s_waitcnt vmcnt(1)
    v_max3_u32 v9, v40, v41, v42
    v_max_u32 v9, v9, v43
    v_cmp_eq_u32 s[60:61], -1, v9
    v_mfma_f32_32x32x16_bf16 v[64:79], a[80:83], v[40:43], v[64:79]
    v_mfma_f32_32x32x16_bf16 v[80:95], a[84:87], v[40:43], v[80:95]
    s_or_b64 s[64:65], s[64:65], s[58:59]
    s_waitcnt vmcnt(0)
    v_max3_u32 v9, v44, v45, v46
    v_max_u32 v9, v9, v47
    v_cmp_eq_u32 s[62:63], -1, v9
    v_mfma_f32_32x32x16_bf16 v[64:79], a[88:91], v[44:47], v[64:79]
    v_mfma_f32_32x32x16_bf16 v[80:95], a[92:95], v[44:47], v[80:95]
    s_or_b64 s[64:65], s[64:65], s[60:61]
    s_nop 3
    s_or_b64 s[64:65], s[64:65], s[62:63]
    s_cbranch_scc1 L_oretry
L_odone:
    s_lshl_b32 s76, s46, 16
    s_lshl_b32 s77, s47, 7
    s_add_u32 s76, s76, s77
    s_nop 2
    ds_write_addtid_b32 v64 offset:0
    ds_write_addtid_b32 v65 offset:256
    ds_write_addtid_b32 v66 offset:512
    ds_write_addtid_b32 v67 offset:768
    ds_write_addtid_b32 v68 offset:1056
    ds_write_addtid_b32 v69 offset:1312
    ds_write_addtid_b32 v70 offset:1568
    ds_write_addtid_b32 v71 offset:1824
    ds_write_addtid_b32 v72 offset:2112
    ds_write_addtid_b32 v73 offset:2368
    ds_write_addtid_b32 v74 offset:2624
    ds_write_addtid_b32 v75 offset:2880
    ds_write_addtid_b32 v76 offset:3168
    ds_write_addtid_b32 v77 offset:3424
    ds_write_addtid_b32 v78 offset:3680
    ds_write_addtid_b32 v79 offset:3936
    ds_write_addtid_b32 v80 offset:4224
    ds_write_addtid_b32 v81 offset:4480
    ds_write_addtid_b32 v82 offset:4736
    ds_write_addtid_b32 v83 offset:4992
    ds_write_addtid_b32 v84 offset:5280
    ds_write_addtid_b32 v85 offset:5536
    ds_write_addtid_b32 v86 offset:5792
    ds_write_addtid_b32 v87 offset:6048
    ds_write_addtid_b32 v88 offset:6336
    ds_write_addtid_b32 v89 offset:6592
    ds_write_addtid_b32 v90 offset:6848
    ds_write_addtid_b32 v91 offset:7104
    ds_write_addtid_b32 v92 offset:7392
    ds_write_addtid_b32 v93 offset:7648
    ds_write_addtid_b32 v94 offset:7904
    ds_write_addtid_b32 v95 offset:8160
    s_waitcnt lgkmcnt(0)
    s_barrier
    ds_read_b128 v[24:27], v5 offset:0
    ds_read_b128 v[28:31], v5 offset:256
    ds_read_b128 v[32:35], v5 offset:16896
    ds_read_b128 v[36:39], v5 offset:17152
    ds_read_b128 v[40:43], v5 offset:33792
    ds_read_b128 v[44:47], v5 offset:34048
    ds_read_b128 v[48:51], v5 offset:50688
    ds_read_b128 v[52:55], v5 offset:50944
    s_waitcnt lgkmcnt(4)
    v_pk_add_f32 v[24:25], v[24:25], v[32:33]
    v_pk_add_f32 v[26:27], v[26:27], v[34:35]
    v_pk_add_f32 v[28:29], v[28:29], v[36:37]
    v_pk_add_f32 v[30:31], v[30:31], v[38:39]
    s_waitcnt lgkmcnt(2)
    v_pk_add_f32 v[24:25], v[24:25], v[40:41]
    v_pk_add_f32 v[26:27], v[26:27], v[42:43]
    v_pk_add_f32 v[28:29], v[28:29], v[44:45]
    v_pk_add_f32 v[30:31], v[30:31], v[46:47]
    s_waitcnt lgkmcnt(0)
    v_pk_add_f32 v[24:25], v[24:25], v[48:49]
    v_pk_add_f32 v[26:27], v[26:27], v[50:51]
    v_pk_add_f32 v[28:29], v[28:29], v[52:53]
    v_pk_add_f32 v[30:31], v[30:31], v[54:55]
    v_cvt_pk_bf16_f32 v16, v24, v28
    v_cvt_pk_bf16_f32 v18, v25, v29
    v_cvt_pk_bf16_f32 v17, v26, v30
    v_cvt_pk_bf16_f32 v19, v27, v31
    s_nop 1
    v_permlane32_swap_b32 v16, v17
    v_permlane32_swap_b32 v18, v19
    s_nop 1
    v_permlane16_swap_b32 v16, v18
    v_permlane16_swap_b32 v17, v19
    buffer_store_dwordx4 v[16:19], v3, s[28:31], s76 offen
L_end:
    s_endpgm
L_oretry:
    s_sub_u32 s80, s80, 1
    s_cmp_eq_u32 s80, 0
    s_cbranch_scc1 L_odone
    s_mov_b32 s76, s75
    s_mov_b64 exec, s[48:49]
    buffer_load_dwordx4 v[16:19], v1, s[24:27], s76 offen offset:0 sc1
    s_mov_b64 exec, s[50:51]
    buffer_load_dwordx4 v[20:23], v1, s[24:27], s76 offen offset:1024 sc1
    s_add_u32 s76, s76, 8192
    s_mov_b64 exec, s[52:53]
    buffer_load_dwordx4 v[24:27], v1, s[24:27], s76 offen offset:0 sc1
    s_mov_b64 exec, s[54:55]
    buffer_load_dwordx4 v[28:31], v1, s[24:27], s76 offen offset:1024 sc1
    s_add_u32 s76, s76, 8192
    s_mov_b64 exec, s[56:57]
    buffer_load_dwordx4 v[32:35], v1, s[24:27], s76 offen offset:0 sc1
    s_mov_b64 exec, s[58:59]
    buffer_load_dwordx4 v[36:39], v1, s[24:27], s76 offen offset:1024 sc1
    s_add_u32 s76, s76, 8192
    s_mov_b64 exec, s[60:61]
    buffer_load_dwordx4 v[40:43], v1, s[24:27], s76 offen offset:0 sc1
    s_mov_b64 exec, s[62:63]
    buffer_load_dwordx4 v[44:47], v1, s[24:27], s76 offen offset:1024 sc1
    s_mov_b64 exec, -1
    s_nop 15
    v_accvgpr_read_b32 v64, a0
    v_accvgpr_read_b32 v65, a1
    v_accvgpr_read_b32 v66, a2
    v_accvgpr_read_b32 v67, a3
    v_accvgpr_read_b32 v68, a4
    v_accvgpr_read_b32 v69, a5
    v_accvgpr_read_b32 v70, a6
    v_accvgpr_read_b32 v71, a7
    v_accvgpr_read_b32 v72, a8
    v_accvgpr_read_b32 v73, a9
    v_accvgpr_read_b32 v74, a10
    v_accvgpr_read_b32 v75, a11
    v_accvgpr_read_b32 v76, a12
    v_accvgpr_read_b32 v77, a13
    v_accvgpr_read_b32 v78, a14
    v_accvgpr_read_b32 v79, a15
    v_accvgpr_read_b32 v80, a16
    v_accvgpr_read_b32 v81, a17
    v_accvgpr_read_b32 v82, a18
    v_accvgpr_read_b32 v83, a19
    v_accvgpr_read_b32 v84, a20
    v_accvgpr_read_b32 v85, a21
    v_accvgpr_read_b32 v86, a22
    v_accvgpr_read_b32 v87, a23
    v_accvgpr_read_b32 v88, a24
    v_accvgpr_read_b32 v89, a25
    v_accvgpr_read_b32 v90, a26
    v_accvgpr_read_b32 v91, a27
    v_accvgpr_read_b32 v92, a28
    v_accvgpr_read_b32 v93, a29
    v_accvgpr_read_b32 v94, a30
    v_accvgpr_read_b32 v95, a31
    v_mul_f32 v64, v8, v64
    v_mul_f32 v65, v8, v65
    v_mul_f32 v66, v8, v66
    v_mul_f32 v67, v8, v67
    v_mul_f32 v68, v8, v68
    v_mul_f32 v69, v8, v69
    v_mul_f32 v70, v8, v70
    v_mul_f32 v71, v8, v71
    v_mul_f32 v72, v8, v72
    v_mul_f32 v73, v8, v73
    v_mul_f32 v74, v8, v74
    v_mul_f32 v75, v8, v75
    v_mul_f32 v76, v8, v76
    v_mul_f32 v77, v8, v77
    v_mul_f32 v78, v8, v78
    v_mul_f32 v79, v8, v79
    v_mul_f32 v80, v8, v80
    v_mul_f32 v81, v8, v81
    v_mul_f32 v82, v8, v82
    v_mul_f32 v83, v8, v83
    v_mul_f32 v84, v8, v84
    v_mul_f32 v85, v8, v85
    v_mul_f32 v86, v8, v86
    v_mul_f32 v87, v8, v87
    v_mul_f32 v88, v8, v88
    v_mul_f32 v89, v8, v89
    v_mul_f32 v90, v8, v90
    v_mul_f32 v91, v8, v91
    v_mul_f32 v92, v8, v92
    v_mul_f32 v93, v8, v93
    v_mul_f32 v94, v8, v94
    v_mul_f32 v95, v8, v95
    s_branch L_ochk
L_fallback:
    s_lshl_b32 s76, s44, 16
    s_add_u32 s76, s76, 2097152
    s_mov_b32 s77, 0
    v_mov_b32 v9, 0xff800000
L_fb1:
    s_add_u32 s78, s76, s77
    buffer_load_dwordx4 v[16:19], v1, s[24:27], s78 offen sc1
    s_waitcnt vmcnt(0)
    v_mfma_f32_32x32x16_bf16 v[64:79], v[16:19], v[12:15], 0
    s_nop 15
    v_max3_f32 v9, v9, v64, v65
    v_max3_f32 v9, v9, v66, v67
    v_max3_f32 v9, v9, v68, v69
    v_max3_f32 v9, v9, v70, v71
    v_max3_f32 v9, v9, v72, v73
    v_max3_f32 v9, v9, v74, v75
    v_max3_f32 v9, v9, v76, v77
    v_max3_f32 v9, v9, v78, v79
    s_add_u32 s77, s77, 1024
    s_cmp_lt_u32 s77, 65536
    s_cbranch_scc1 L_fb1
    v_mov_b32 v2, v9
    s_nop 1
    v_permlane32_swap_b32 v2, v9
    s_nop 1
    v_max_f32 v9, v9, v2
    v_sub_f32 v80, 0, v9
    v_mov_b32 v48, 0
    v_sub_f32 v81, 0, v9
    v_mov_b32 v49, 0
    v_sub_f32 v82, 0, v9
    v_mov_b32 v50, 0
    v_sub_f32 v83, 0, v9
    v_mov_b32 v51, 0
    v_sub_f32 v84, 0, v9
    v_mov_b32 v52, 0
    v_sub_f32 v85, 0, v9
    v_mov_b32 v53, 0
    v_sub_f32 v86, 0, v9
    v_mov_b32 v54, 0
    v_sub_f32 v87, 0, v9
    v_mov_b32 v55, 0
    v_sub_f32 v88, 0, v9
    v_mov_b32 v56, 0
    v_sub_f32 v89, 0, v9
    v_mov_b32 v57, 0
    v_sub_f32 v90, 0, v9
    v_mov_b32 v58, 0
    v_sub_f32 v91, 0, v9
    v_mov_b32 v59, 0
    v_sub_f32 v92, 0, v9
    v_mov_b32 v60, 0
    v_sub_f32 v93, 0, v9
    v_mov_b32 v61, 0
    v_sub_f32 v94, 0, v9
    v_mov_b32 v62, 0
    v_sub_f32 v95, 0, v9
    v_mov_b32 v63, 0
    v_subrev_u32 v2, 32768, v3
    s_mov_b32 s77, 0
L_fb2:
    s_add_u32 s78, s76, s77
    s_add_u32 s79, s78, 2097152
    buffer_load_dwordx4 v[16:19], v1, s[24:27], s78 offen sc1
    s_mov_b64 exec, s[40:41]
    buffer_load_dwordx4 v[24:27], v2, s[24:27], s79 offen sc1
    buffer_load_dwordx4 v[28:31], v2, s[24:27], s79 offen offset:512 sc1
    s_mov_b64 exec, -1
    s_waitcnt vmcnt(0)
    v_mfma_f32_32x32x16_bf16 v[64:79], v[16:19], v[12:15], v[80:95]
    s_nop 15
    v_exp_f32 v64, v64
    v_exp_f32 v65, v65
    v_exp_f32 v66, v66
    v_exp_f32 v67, v67
    v_exp_f32 v68, v68
    v_exp_f32 v69, v69
    v_exp_f32 v70, v70
    v_exp_f32 v71, v71
    v_exp_f32 v72, v72
    v_exp_f32 v73, v73
    v_exp_f32 v74, v74
    v_exp_f32 v75, v75
    v_exp_f32 v76, v76
    v_exp_f32 v77, v77
    v_exp_f32 v78, v78
    v_exp_f32 v79, v79
    s_nop 0
    s_nop 1
    v_smfmac_f32_32x32x32_bf16 v[48:63], v[24:27], v[64:71], v40
    v_smfmac_f32_32x32x32_bf16 v[48:63], v[28:31], v[72:79], v40
    s_add_u32 s77, s77, 1024
    s_cmp_lt_u32 s77, 65536
    s_cbranch_scc1 L_fb2
    s_nop 15
    s_branch L_norm
L_G:
    s_waitcnt vmcnt(0) lgkmcnt(0)
    s_barrier
    s_cmp_lg_u32 s3, 0
    s_cbranch_scc1 L_fs_18
    v_mov_b32 v124, 0
    v_mov_b32 v125, 1
    s_mov_b64 exec, 1
    buffer_store_dword v125, v124, s[24:27], s85 offen sc1
    s_mov_b64 exec, -1
L_fs_18:
    s_cmp_ge_u32 s3, 4
    s_cbranch_scc1 L_gs_19
    v_lshrrev_b32 v10, 5, v0
    v_lshlrev_b32 v10, 4, v10
    s_add_u32 s76, s92, 0
    s_and_b32 s76, s76, 7
    s_lshl_b32 s76, s76, 7
    buffer_load_dwordx4 v[76:79], v10, s[36:39], s76 offen offset:0
    buffer_load_dwordx4 v[80:83], v10, s[36:39], s76 offen offset:32
    buffer_load_dwordx4 v[84:87], v10, s[36:39], s76 offen offset:64
    buffer_load_dwordx4 v[88:91], v10, s[36:39], s76 offen offset:96
    s_add_u32 s76, s92, 1
    s_and_b32 s76, s76, 7
    s_lshl_b32 s76, s76, 7
    buffer_load_dwordx4 v[92:95], v10, s[36:39], s76 offen offset:0
    buffer_load_dwordx4 v[96:99], v10, s[36:39], s76 offen offset:32
    buffer_load_dwordx4 v[100:103], v10, s[36:39], s76 offen offset:64
    buffer_load_dwordx4 v[104:107], v10, s[36:39], s76 offen offset:96
    s_waitcnt vmcnt(0)
    v_mfma_f32_32x32x16_bf16 v[44:59], v[76:79], a[0:3], 0
    v_mfma_f32_32x32x16_bf16 v[44:59], v[80:83], a[4:7], v[44:59]
    v_mfma_f32_32x32x16_bf16 v[44:59], v[84:87], a[8:11], v[44:59]
    v_mfma_f32_32x32x16_bf16 v[44:59], v[88:91], a[12:15], v[44:59]
    v_mfma_f32_32x32x16_bf16 v[44:59], v[92:95], a[16:19], v[44:59]
    v_mfma_f32_32x32x16_bf16 v[44:59], v[96:99], a[20:23], v[44:59]
    v_mfma_f32_32x32x16_bf16 v[44:59], v[100:103], a[24:27], v[44:59]
    v_mfma_f32_32x32x16_bf16 v[44:59], v[104:107], a[28:31], v[44:59]
    s_nop 15
    s_add_u32 s76, s92, 2
    s_and_b32 s76, s76, 7
    s_lshl_b32 s76, s76, 7
    buffer_load_dwordx4 v[76:79], v10, s[36:39], s76 offen offset:0
    buffer_load_dwordx4 v[80:83], v10, s[36:39], s76 offen offset:32
    buffer_load_dwordx4 v[84:87], v10, s[36:39], s76 offen offset:64
    buffer_load_dwordx4 v[88:91], v10, s[36:39], s76 offen offset:96
    s_add_u32 s76, s92, 3
    s_and_b32 s76, s76, 7
    s_lshl_b32 s76, s76, 7
    buffer_load_dwordx4 v[92:95], v10, s[36:39], s76 offen offset:0
    buffer_load_dwordx4 v[96:99], v10, s[36:39], s76 offen offset:32
    buffer_load_dwordx4 v[100:103], v10, s[36:39], s76 offen offset:64
    buffer_load_dwordx4 v[104:107], v10, s[36:39], s76 offen offset:96
    s_waitcnt vmcnt(0)
    v_mfma_f32_32x32x16_bf16 v[44:59], v[76:79], a[32:35], v[44:59]
    v_mfma_f32_32x32x16_bf16 v[44:59], v[80:83], a[36:39], v[44:59]
    v_mfma_f32_32x32x16_bf16 v[44:59], v[84:87], a[40:43], v[44:59]
    v_mfma_f32_32x32x16_bf16 v[44:59], v[88:91], a[44:47], v[44:59]
    v_mfma_f32_32x32x16_bf16 v[44:59], v[92:95], a[48:51], v[44:59]
    v_mfma_f32_32x32x16_bf16 v[44:59], v[96:99], a[52:55], v[44:59]
    v_mfma_f32_32x32x16_bf16 v[44:59], v[100:103], a[56:59], v[44:59]
    v_mfma_f32_32x32x16_bf16 v[44:59], v[104:107], a[60:63], v[44:59]
    s_nop 15
    s_add_u32 s76, s92, 4
    s_and_b32 s76, s76, 7
    s_lshl_b32 s76, s76, 7
    buffer_load_dwordx4 v[76:79], v10, s[36:39], s76 offen offset:0
    buffer_load_dwordx4 v[80:83], v10, s[36:39], s76 offen offset:32
    buffer_load_dwordx4 v[84:87], v10, s[36:39], s76 offen offset:64
    buffer_load_dwordx4 v[88:91], v10, s[36:39], s76 offen offset:96
    s_add_u32 s76, s92, 5
    s_and_b32 s76, s76, 7
    s_lshl_b32 s76, s76, 7
    buffer_load_dwordx4 v[92:95], v10, s[36:39], s76 offen offset:0
    buffer_load_dwordx4 v[96:99], v10, s[36:39], s76 offen offset:32
    buffer_load_dwordx4 v[100:103], v10, s[36:39], s76 offen offset:64
    buffer_load_dwordx4 v[104:107], v10, s[36:39], s76 offen offset:96
    s_waitcnt vmcnt(0)
    v_mfma_f32_32x32x16_bf16 v[44:59], v[76:79], a[64:67], v[44:59]
    v_mfma_f32_32x32x16_bf16 v[44:59], v[80:83], a[68:71], v[44:59]
    v_mfma_f32_32x32x16_bf16 v[44:59], v[84:87], a[72:75], v[44:59]
    v_mfma_f32_32x32x16_bf16 v[44:59], v[88:91], a[76:79], v[44:59]
    v_mfma_f32_32x32x16_bf16 v[44:59], v[92:95], a[80:83], v[44:59]
    v_mfma_f32_32x32x16_bf16 v[44:59], v[96:99], a[84:87], v[44:59]
    v_mfma_f32_32x32x16_bf16 v[44:59], v[100:103], a[88:91], v[44:59]
    v_mfma_f32_32x32x16_bf16 v[44:59], v[104:107], a[92:95], v[44:59]
    s_nop 15
    s_add_u32 s76, s92, 6
    s_and_b32 s76, s76, 7
    s_lshl_b32 s76, s76, 7
    buffer_load_dwordx4 v[76:79], v10, s[36:39], s76 offen offset:0
    buffer_load_dwordx4 v[80:83], v10, s[36:39], s76 offen offset:32
    buffer_load_dwordx4 v[84:87], v10, s[36:39], s76 offen offset:64
    buffer_load_dwordx4 v[88:91], v10, s[36:39], s76 offen offset:96
    s_add_u32 s76, s92, 7
    s_and_b32 s76, s76, 7
    s_lshl_b32 s76, s76, 7
    buffer_load_dwordx4 v[92:95], v10, s[36:39], s76 offen offset:0
    buffer_load_dwordx4 v[96:99], v10, s[36:39], s76 offen offset:32
    buffer_load_dwordx4 v[100:103], v10, s[36:39], s76 offen offset:64
    buffer_load_dwordx4 v[104:107], v10, s[36:39], s76 offen offset:96
    s_waitcnt vmcnt(0)
    v_mfma_f32_32x32x16_bf16 v[44:59], v[76:79], a[96:99], v[44:59]
    v_mfma_f32_32x32x16_bf16 v[44:59], v[80:83], a[100:103], v[44:59]
    v_mfma_f32_32x32x16_bf16 v[44:59], v[84:87], a[104:107], v[44:59]
    v_mfma_f32_32x32x16_bf16 v[44:59], v[88:91], a[108:111], v[44:59]
    v_mfma_f32_32x32x16_bf16 v[44:59], v[92:95], a[112:115], v[44:59]
    v_mfma_f32_32x32x16_bf16 v[44:59], v[96:99], a[116:119], v[44:59]
    v_mfma_f32_32x32x16_bf16 v[44:59], v[100:103], a[120:123], v[44:59]
    v_mfma_f32_32x32x16_bf16 v[44:59], v[104:107], a[124:127], v[44:59]
    s_nop 15
    v_mul_f32 v44, 0xbfb8aa3b, v44
    v_exp_f32 v44, v44
    s_nop 0
    v_add_f32 v44, 1.0, v44
    v_rcp_f32 v44, v44
    s_lshl_b32 s76, s42, 2
    s_add_u32 s76, s76, s3
    s_lshl_b32 s76, s76, 7
    s_add_u32 s76, s76, 14680064
    v_lshlrev_b32 v10, 2, v0
    s_mov_b64 exec, 0xffffffff
    buffer_store_dword v44, v10, s[24:27], s76 offen sc1
    s_mov_b64 exec, -1
L_gs_19:
    s_cmp_lg_u32 s3, 0
    s_cbranch_scc1 L_pi_20
    s_lshr_b32 s76, s44, 1
    s_add_u32 s77, s76, 16
    s_mul_i32 s77, s77, 171
    s_lshr_b32 s77, s77, 9
    s_add_u32 s78, s76, 32
    s_mul_i32 s78, s78, 171
    s_lshr_b32 s78, s78, 9
    s_add_u32 s79, s76, 0
    s_mul_i32 s79, s79, 171
    s_lshr_b32 s79, s79, 9
    s_lshl_b32 s76, s45, 1
    v_mov_b32 v124, s78
    v_mov_b32 v125, s77
    v_cmp_gt_u32 vcc, 16, v0
    v_cndmask_b32 v124, v124, v125, vcc
    v_mov_b32 v125, s79
    v_cmp_gt_u32 vcc, 32, v0
    v_cndmask_b32 v124, v125, v124, vcc
    v_and_b32 v125, 1, v0
    v_add_u32 v125, s76, v125
    v_and_b32 v126, 15, v0
    v_cndmask_b32 v126, v125, v126, vcc
    v_lshlrev_b32 v124, 9, v124
    v_lshrrev_b32 v125, 2, v126
    v_lshl_add_u32 v124, v125, 7, v124
    v_and_b32 v126, 3, v126
    v_lshl_add_u32 v126, v126, 2, v124
    v_add_u32 v126, 0xe80000, v126
    buffer_load_dword v125, v126, s[24:27], 0 offen sc1
L_pi_20:
    s_cmp_lg_u32 s3, 0
    s_cbranch_scc1 L_pd_21
    s_mov_b32 s80, 400000
    s_waitcnt vmcnt(0)
L_pl_22:
    v_cmp_ne_u32 vcc, 1, v125
    s_nop 4
    s_cbranch_vccz L_pd_21
    s_sub_u32 s80, s80, 1
    s_cmp_eq_u32 s80, 0
    s_cbranch_scc1 L_pd_21
    buffer_load_dword v125, v126, s[24:27], 0 offen sc1
    s_waitcnt vmcnt(0)
    s_branch L_pl_22
L_pd_21:
    s_waitcnt vmcnt(0)
    s_barrier
    v_lshrrev_b32 v9, 5, v0
    v_and_b32 v3, 15, v0
    v_lshlrev_b32 v3, 4, v3
    v_lshl_add_u32 v3, v9, 8, v3
    v_add_u32 v43, 98304, v3
    v_add_u32 v3, 32768, v3
    v_add_u32 v41, 28672, v1
    v_add_u32 v42, 94208, v1
    v_bfe_u32 v4, v0, 4, 1
    v_lshlrev_b32 v5, 2, v4
    v_xor_b32 v5, v5, v0
    v_and_b32 v5, 7, v5
    v_lshrrev_b32 v6, 3, v0
    v_lshlrev_b32 v6, 10, v6
    v_lshl_add_u32 v8, v5, 4, v6
    v_bfe_u32 v5, v0, 2, 2
    v_lshl_add_u32 v6, v9, 2, v5
    v_lshlrev_b32 v6, 7, v6
    v_lshl_add_u32 v6, v4, 5, v6
    v_and_b32 v7, 3, v0
    v_lshl_add_u32 v6, v7, 3, v6
    v_lshrrev_b32 v5, 1, v5
    v_lshl_add_u32 v6, v5, 6, v6
    s_lshr_b32 s76, s3, 1
    s_lshl_b32 s77, s76, 12
    v_add_u32 v4, s77, v6
    v_xor_b32 v5, 64, v4
    s_lshl_b32 s77, s3, 14
    s_lshl_b32 s78, s47, 7
    s_add_u32 s72, s77, s78
    s_lshl_b32 s73, s3, 11
    s_and_b32 s77, s3, 1
    s_lshl_b32 s78, s46, 1
    s_add_u32 s77, s77, s78
    s_lshl_b32 s76, s76, 1
    s_mul_i32 s78, s77, 88
    s_add_u32 s78, s78, s76
    s_lshl_b32 s78, s78, 10
    s_add_u32 s74, s78, 8388608
    s_lshl_b32 s78, s77, 5
    s_add_u32 s78, s78, s76
    s_lshl_b32 s78, s78, 10
    s_add_u32 s75, s78, 6291456
    v_and_b32 v9, 27, v0
    v_mov_b32 v2, 0x3f803f80
    v_cmp_eq_u32 vcc, 16, v9
    v_cndmask_b32 v9, 0, v2, vcc
    v_mov_b32 v40, 0xdddddddd
    s_lshr_b32 s76, s46, 1
    s_add_u32 s76, s76, 16
    s_lshl_b32 s77, s45, 1
    s_add_u32 s77, s77, 16
    s_lshr_b32 s78, s46, 2
    v_and_b32 v124, 1, v0
    v_add_u32 v124, s77, v124
    v_mov_b32 v125, s76
    v_cmp_gt_u32 vcc, 16, v0
    v_cndmask_b32 v124, v124, v125, vcc
    v_and_b32 v10, 15, v0
    v_cndmask_b32 v125, 15, v10, vcc
    v_cmp_gt_u32 vcc, 32, v0
    s_and_b32 s79, s78, 1
    s_lshl_b32 s79, s79, 2
    v_and_b32 v10, 3, v0
    v_add_u32 v10, s79, v10
    v_cndmask_b32 v10, v10, v125, vcc
    v_bfe_u32 v125, v0, 2, 1
    v_lshlrev_b32 v125, 3, v125
    v_cndmask_b32 v125, v125, 0, vcc
    v_add_u32 v10, v10, v125
    s_lshr_b32 s78, s78, 1
    v_bfe_u32 v125, v0, 3, 2
    v_lshlrev_b32 v125, 2, v125
    v_add_u32 v125, s78, v125
    v_cndmask_b32 v124, v125, v124, vcc
    v_lshlrev_b32 v124, 9, v124
    v_lshrrev_b32 v125, 2, v10
    v_lshl_add_u32 v124, v125, 7, v124
    v_and_b32 v10, 3, v10
    v_lshl_add_u32 v10, v10, 2, v124
    v_add_u32 v10, 0xe80000, v10
    s_lshl_b32 s76, s44, 16
    s_lshl_b32 s77, s45, 3
    s_add_u32 s77, s77, s3
    s_lshl_b32 s77, s77, 10
    s_add_u32 s77, s77, s76
    buffer_load_dwordx4 v[12:15], v1, s[24:27], s77 offen sc1
    s_and_b32 s77, s3, 3
    s_lshl_b32 s77, s77, 10
    s_lshr_b32 s78, s3, 2
    s_lshl_b32 s88, s3, 10
    s_lshl_b32 s78, s78, 21
    s_add_u32 s78, s78, 2097152
    s_add_u32 s78, s78, s76
    s_add_u32 s87, s78, s77
    s_add_u32 m0, s88, 28672
    s_nop 0
    buffer_load_dwordx4 v1, s[24:27], s87 offen sc1 lds
    s_add_u32 s87, s87, 4096
    s_add_u32 m0, s88, 36864
    s_nop 0
    buffer_load_dwordx4 v1, s[24:27], s87 offen sc1 lds
    s_add_u32 s87, s87, 4096
    s_add_u32 m0, s88, 45056
    s_nop 0
    buffer_load_dwordx4 v1, s[24:27], s87 offen sc1 lds
    s_add_u32 s87, s87, 4096
    s_add_u32 m0, s88, 53248
    s_nop 0
    buffer_load_dwordx4 v1, s[24:27], s87 offen sc1 lds
    s_add_u32 s87, s87, 4096
    s_add_u32 m0, s88, 61440
    s_nop 0
    buffer_load_dwordx4 v1, s[24:27], s87 offen sc1 lds
    s_add_u32 s87, s87, 4096
    s_add_u32 m0, s88, 69632
    s_nop 0
    buffer_load_dwordx4 v1, s[24:27], s87 offen sc1 lds
    s_add_u32 s87, s87, 4096
    s_add_u32 m0, s88, 77824
    s_nop 0
    buffer_load_dwordx4 v1, s[24:27], s87 offen sc1 lds
    s_add_u32 s87, s87, 4096
    s_add_u32 m0, s88, 86016
    s_nop 0
    buffer_load_dwordx4 v1, s[24:27], s87 offen sc1 lds
    s_add_u32 s87, s87, 4096
    s_add_u32 m0, s88, 94208
    s_nop 0
    buffer_load_dwordx4 v1, s[24:27], s87 offen sc1 lds
    s_add_u32 s87, s87, 4096
    s_add_u32 m0, s88, 102400
    s_nop 0
    buffer_load_dwordx4 v1, s[24:27], s87 offen sc1 lds
    s_add_u32 s87, s87, 20480
    s_add_u32 m0, s88, 143360
    s_nop 0
    buffer_load_dwordx4 v1, s[24:27], s87 offen sc1 lds
    s_add_u32 s87, s87, 4096
    s_add_u32 m0, s88, 151552
    s_nop 0
    buffer_load_dwordx4 v1, s[24:27], s87 offen sc1 lds
    s_sub_u32 s87, s87, 20480
    buffer_load_dword v124, v1, s[36:39], 0 offen
    buffer_load_dword v124, v1, s[36:39], 0 offen
    buffer_load_dword v124, v1, s[36:39], 0 offen
    s_branch L_att
L_codeend:
.section .rodata,"a"
.p2align 6
.amdhsa_kernel gated_mix__softmax_full_mha__geglu_ffn__prompt_kernel
  .amdhsa_next_free_vgpr 256
  .amdhsa_next_free_sgpr 102
  .amdhsa_accum_offset 128
  .amdhsa_group_segment_fixed_size 0
  .amdhsa_kernarg_size 88
  .amdhsa_user_sgpr_count 2
  .amdhsa_user_sgpr_kernarg_segment_ptr 1
  .amdhsa_system_sgpr_workgroup_id_x 1
.end_amdhsa_kernel
```
